```python
import torch

def _softmax(x, axis=-1):
    return torch.softmax(x, dim=axis)
def _gelu(x):
    return torch.nn.functional.gelu(x, approximate="tanh")
def _silu(x):
    return torch.nn.functional.silu(x)
def _sigmoid(x):
    return torch.sigmoid(x)
def _layernorm(x, axis=-1, eps=1e-5):
    m = x.mean(dim=axis, keepdim=True)
    v = x.var(dim=axis, keepdim=True, unbiased=False)
    return (x - m) / torch.sqrt(v + eps)
def _scatter_add(tgt, idx, src, axis=0):
    return tgt.clone().index_add_(axis, idx, src)
def _segment_sum(src, seg, n):
    out = torch.zeros((n,) + src.shape[1:], dtype=src.dtype)
    return out.index_add_(0, seg, src)
def _pad(x, pw):
    flat = tuple(v for pair in reversed(pw) for v in pair)
    return torch.nn.functional.pad(x, flat)

kernel_name = 'standalone__edge_featured_mpnn_gatedgcn__graph'

def setup_inputs():

    _w = (lambda a: (lambda t: t.to(torch.bfloat16) if t.is_floating_point() else t)(torch.as_tensor(a)))
    N, deg, D, De = 25000, 16, 128, max(16, 1)
    E = N * deg
    return {
        "x": _w((lambda *s: torch.randn(*s, dtype=torch.bfloat16) * 0.4)(N, D)),
        "e_attr": _w((lambda *s: torch.randn(*s, dtype=torch.bfloat16) * 0.4)(E, De)),
        "src": _w((lambda lo, hi, *s: torch.randint(lo, hi, s))(0, N, E).to(torch.int64)),
        "dst": _w((lambda lo, hi, *s: torch.randint(lo, hi, s))(0, N, E).to(torch.int64)),
        "w_a": _w((lambda *s: torch.randn(*s, dtype=torch.bfloat16) * 0.4)(D, D)),
        "w_b": _w((lambda *s: torch.randn(*s, dtype=torch.bfloat16) * 0.4)(D, D)),
        "w_c": _w((lambda *s: torch.randn(*s, dtype=torch.bfloat16) * 0.4)(De, D)),
        "w_u": _w((lambda *s: torch.randn(*s, dtype=torch.bfloat16) * 0.05)(D, D)),
        "w_v": _w((lambda *s: torch.randn(*s, dtype=torch.bfloat16) * 0.05)(D, D)),
    }

def reference(x, e_attr, src, dst, w_a, w_b, w_c, w_u, w_v):
    N, D = x.shape
    hv = x @ w_v
    g = x[dst] @ w_a + x[src] @ w_b + e_attr @ w_c
    eta = _sigmoid(g)
    denom = _segment_sum(eta, dst, N) + 1e-6
    eta_n = eta / denom[dst]
    agg = _segment_sum(eta_n * hv[src], dst, N)
    z = x @ w_u + agg
    relu_z = torch.where(z > 0, z, 0 * z)
    return x + relu_z
```

```asm
; @launch kernel=gsort_kernel grid=(256,1,1) block=(512,1,1) lds=135680
; @launch kernel=gmain_kernel grid=(512,1,1) block=(256,1,1) lds=78928
.amdgcn_target "amdgcn-amd-amdhsa--gfx950"
.text
.globl gsort_kernel
.p2align 8
.type gsort_kernel,@function
gsort_kernel:
    s_load_dwordx8 s[4:11], s[0:1], 0
    s_load_dwordx8 s[40:47], s[0:1], 32
    s_load_dwordx2 s[48:49], s[0:1], 64
    s_load_dwordx2 s[12:13], s[0:1], 88
    v_lshrrev_b32 v2, 6, v0
    v_lshlrev_b32 v40, 4, v0
    v_bfe_u32 v56, v0, 4, 1
    v_bfe_u32 v57, v0, 5, 1
    v_and_b32 v20, 63, v0
    v_readfirstlane_b32 s33, v2
    s_cmp_ge_u32 s2, 256
    s_cbranch_scc1 K1_END
    s_add_u32 s2, s2, 192
    s_and_b32 s2, s2, 255
    s_cmp_ge_u32 s2, 196
    s_cbranch_scc1 K1_OTHER
    s_lshr_b32 s35, s2, 3
    s_and_b32 s36, s2, 7
    s_min_u32 s14, s36, 4
    s_mul_i32 s36, s36, 24
    s_add_u32 s36, s36, s14
    s_add_u32 s36, s36, s35
    s_lshl_b32 s37, s36, 7
    v_bfe_u32 v43, v0, 4, 2
    v_lshlrev_b32 v43, 6, v43
    v_xor_b32 v43, v43, v40
    v_lshl_add_u32 v54, v57, 3, v56
    s_lshr_b32 s32, s33, 2
    s_lshl_b32 s14, s32, 4
    s_and_b32 s30, s33, 3
    s_lshl1_add_u32 s14, s30, s14
    s_add_u32 s14, s14, s37
    v_add_u32 v54, s14, v54
    v_and_b32 v55, 15, v0
    v_lshlrev_b32 v59, 3, v56
    v_xor_b32 v55, v55, v59
    v_lshlrev_b32 v55, 4, v55
    s_mul_i32 s38, s33, 1040
    s_add_u32 s38, s38, 65536
    s_lshl_b32 s39, s33, 10
    s_mov_b32 m0, s38
    s_waitcnt lgkmcnt(0)
    s_mov_b32 s60, s4
    s_and_b32 s61, s5, 0xffff
    s_or_b32 s61, s61, 0x1000000
    s_mov_b32 s62, 0x61a8
    s_mov_b32 s63, 0x20000
    buffer_load_dwordx4 v[54:55], s[60:63], 0 idxen offen lds
    s_add_u32 m0, s38, 8320
    v_add_u32 v54, 32, v54
    buffer_load_dwordx4 v[54:55], s[60:63], 0 idxen offen lds
    s_mov_b32 s52, s42
    s_and_b32 s53, s43, 0xffff
    s_mov_b32 s54, 0x8000
    s_mov_b32 s55, 0x20000
    s_add_u32 m0, s39, 0
    s_movk_i32 s14, 0
    buffer_load_dwordx4 v43, s[52:55], s14 offen lds
    s_add_u32 m0, s39, 8192
    s_movk_i32 s14, 8192
    buffer_load_dwordx4 v43, s[52:55], s14 offen lds
    s_add_u32 m0, s39, 16384
    s_movk_i32 s14, 16384
    buffer_load_dwordx4 v43, s[52:55], s14 offen lds
    s_add_u32 m0, s39, 24576
    s_movk_i32 s14, 24576
    buffer_load_dwordx4 v43, s[52:55], s14 offen lds
    s_barrier
    s_mov_b32 s56, s48
    s_and_b32 s57, s49, 0xffff
    s_mov_b32 s58, 0x8000
    s_mov_b32 s59, 0x20000
    s_add_u32 m0, s39, 32768
    s_movk_i32 s14, 0
    buffer_load_dwordx4 v43, s[56:59], s14 offen lds
    s_add_u32 m0, s39, 40960
    s_movk_i32 s14, 8192
    buffer_load_dwordx4 v43, s[56:59], s14 offen lds
    s_add_u32 m0, s39, 49152
    s_movk_i32 s14, 16384
    buffer_load_dwordx4 v43, s[56:59], s14 offen lds
    s_add_u32 m0, s39, 57344
    s_movk_i32 s14, 24576
    buffer_load_dwordx4 v43, s[56:59], s14 offen lds
    v_bfe_u32 v60, v0, 2, 2
    v_lshl_add_u32 v61, v57, 6, v60
    v_xor_b32 v60, s30, v60
    v_lshlrev_b32 v60, 6, v60
    v_lshl_add_u32 v60, v61, 8, v60
    v_and_b32 v61, 3, v0
    v_lshl_add_u32 v60, v61, 3, v60
    v_lshl_add_u32 v60, v56, 5, v60
    v_bfe_u32 v61, v0, 1, 2
    v_lshl_or_b32 v61, v56, 2, v61
    v_mul_u32_u24 v61, 1040, v61
    v_and_b32 v62, 1, v0
    v_bfe_u32 v63, v0, 3, 1
    v_lshl_or_b32 v63, v63, 1, v62
    v_lshl_add_u32 v61, v63, 8, v61
    s_mul_i32 s14, s32, 8320
    s_add_u32 s14, s14, 65536
    v_xor_b32 v62, v62, v57
    v_lshl_add_u32 v61, v62, 7, v61
    v_add_u32 v61, s14, v61
    s_mul_i32 s14, s33, 4608
    s_add_u32 s14, s14, 98816
    v_and_b32 v62, 31, v0
    v_mul_u32_u24 v62, 144, v62
    v_lshl_add_u32 v62, v57, 6, v62
    v_add_u32 v62, s14, v62
    v_lshrrev_b32 v58, 3, v20
    v_and_b32 v59, 7, v0
    v_lshlrev_b32 v59, 4, v59
    v_mul_u32_u24 v63, 144, v58
    v_add3_u32 v63, v63, v59, s14
    s_lshl_b32 s14, s32, 5
    s_add_u32 s14, s14, s37
    s_lshl_b32 s14, s14, 9
    s_lshl_b32 s30, s30, 7
    s_add_u32 s14, s14, s30
    v_lshl_add_u32 v59, v58, 9, v59
    v_add_u32 v59, s14, v59
    s_add_u32 s12, s12, 0x400000
    s_addc_u32 s13, s13, 0
    s_mov_b32 s16, s12
    s_and_b32 s17, s13, 0xffff
    s_mov_b32 s18, 0xc35000
    s_mov_b32 s19, 0x20000
    s_mov_b32 s15, 0xbfb8aa3b
    s_waitcnt vmcnt(4)
    s_barrier
    ds_read_b64_tr_b16 v[64:65], v60 offset:0
    ds_read_b64_tr_b16 v[66:67], v60 offset:1024
    ds_read_b128 v[128:131], v61 offset:0
    ds_read_b64_tr_b16 v[68:69], v60 offset:2048
    ds_read_b64_tr_b16 v[70:71], v60 offset:3072
    ds_read_b128 v[132:135], v61 offset:16
    ds_read_b64_tr_b16 v[72:73], v60 offset:4096
    ds_read_b64_tr_b16 v[74:75], v60 offset:5120
    ds_read_b128 v[136:139], v61 offset:32
    ds_read_b64_tr_b16 v[76:77], v60 offset:6144
    ds_read_b64_tr_b16 v[78:79], v60 offset:7168
    ds_read_b128 v[140:143], v61 offset:48
    ds_read_b64_tr_b16 v[80:81], v60 offset:8192
    ds_read_b64_tr_b16 v[82:83], v60 offset:9216
    ds_read_b128 v[144:147], v61 offset:64
    ds_read_b64_tr_b16 v[84:85], v60 offset:10240
    ds_read_b64_tr_b16 v[86:87], v60 offset:11264
    ds_read_b128 v[148:151], v61 offset:80
    ds_read_b64_tr_b16 v[88:89], v60 offset:12288
    ds_read_b64_tr_b16 v[90:91], v60 offset:13312
    ds_read_b128 v[152:155], v61 offset:96
    ds_read_b64_tr_b16 v[92:93], v60 offset:14336
    ds_read_b64_tr_b16 v[94:95], v60 offset:15360
    ds_read_b128 v[156:159], v61 offset:112
    s_add_u32 m0, s38, 16640
    v_add_u32 v54, 32, v54
    buffer_load_dwordx4 v[54:55], s[60:63], 0 idxen offen lds
    s_add_u32 m0, s38, 24960
    v_add_u32 v54, 32, v54
    buffer_load_dwordx4 v[54:55], s[60:63], 0 idxen offen lds
    s_waitcnt lgkmcnt(12)
    v_mfma_f32_32x32x16_bf16 v[160:175], v[64:67], v[128:131], 0
    v_mfma_f32_32x32x16_bf16 v[160:175], v[68:71], v[132:135], v[160:175]
    v_mfma_f32_32x32x16_bf16 v[160:175], v[72:75], v[136:139], v[160:175]
    v_mfma_f32_32x32x16_bf16 v[160:175], v[76:79], v[140:143], v[160:175]
    s_waitcnt lgkmcnt(0)
    v_mfma_f32_32x32x16_bf16 v[160:175], v[80:83], v[144:147], v[160:175]
    v_mfma_f32_32x32x16_bf16 v[160:175], v[84:87], v[148:151], v[160:175]
    v_mfma_f32_32x32x16_bf16 v[160:175], v[88:91], v[152:155], v[160:175]
    v_mfma_f32_32x32x16_bf16 v[160:175], v[92:95], v[156:159], v[160:175]
    s_waitcnt vmcnt(2)
    s_barrier
    ds_read_b64_tr_b16 v[96:97], v60 offset:32768
    ds_read_b64_tr_b16 v[98:99], v60 offset:33792
    ds_read_b64_tr_b16 v[100:101], v60 offset:34816
    ds_read_b64_tr_b16 v[102:103], v60 offset:35840
    ds_read_b64_tr_b16 v[104:105], v60 offset:36864
    ds_read_b64_tr_b16 v[106:107], v60 offset:37888
    ds_read_b64_tr_b16 v[108:109], v60 offset:38912
    ds_read_b64_tr_b16 v[110:111], v60 offset:39936
    ds_read_b64_tr_b16 v[112:113], v60 offset:40960
    ds_read_b64_tr_b16 v[114:115], v60 offset:41984
    ds_read_b64_tr_b16 v[116:117], v60 offset:43008
    ds_read_b64_tr_b16 v[118:119], v60 offset:44032
    ds_read_b64_tr_b16 v[120:121], v60 offset:45056
    ds_read_b64_tr_b16 v[122:123], v60 offset:46080
    ds_read_b64_tr_b16 v[124:125], v60 offset:47104
    ds_read_b64_tr_b16 v[126:127], v60 offset:48128
    v_mul_f32 v160, s15, v160
    v_mul_f32 v161, s15, v161
    v_mul_f32 v162, s15, v162
    v_mul_f32 v163, s15, v163
    v_mul_f32 v164, s15, v164
    v_mul_f32 v165, s15, v165
    v_mul_f32 v166, s15, v166
    v_mul_f32 v167, s15, v167
    v_mul_f32 v168, s15, v168
    v_mul_f32 v169, s15, v169
    v_mul_f32 v170, s15, v170
    v_mul_f32 v171, s15, v171
    v_mul_f32 v172, s15, v172
    v_mul_f32 v173, s15, v173
    v_mul_f32 v174, s15, v174
    v_mul_f32 v175, s15, v175
    s_waitcnt lgkmcnt(0)
    v_mfma_f32_32x32x16_bf16 v[176:191], v[96:99], v[128:131], 0
    v_cvt_pk_bf16_f32 v224, v160, v161
    v_mfma_f32_32x32x16_bf16 v[176:191], v[100:103], v[132:135], v[176:191]
    v_cvt_pk_bf16_f32 v225, v162, v163
    v_mfma_f32_32x32x16_bf16 v[176:191], v[104:107], v[136:139], v[176:191]
    v_cvt_pk_bf16_f32 v226, v164, v165
    v_mfma_f32_32x32x16_bf16 v[176:191], v[108:111], v[140:143], v[176:191]
    v_cvt_pk_bf16_f32 v227, v166, v167
    v_mfma_f32_32x32x16_bf16 v[176:191], v[112:115], v[144:147], v[176:191]
    v_cvt_pk_bf16_f32 v228, v168, v169
    v_mfma_f32_32x32x16_bf16 v[176:191], v[116:119], v[148:151], v[176:191]
    v_cvt_pk_bf16_f32 v229, v170, v171
    v_mfma_f32_32x32x16_bf16 v[176:191], v[120:123], v[152:155], v[176:191]
    v_cvt_pk_bf16_f32 v230, v172, v173
    v_mfma_f32_32x32x16_bf16 v[176:191], v[124:127], v[156:159], v[176:191]
    v_cvt_pk_bf16_f32 v231, v174, v175
    s_waitcnt vmcnt(0)
    s_barrier
    ds_read_b128 v[128:131], v61 offset:16640
    ds_read_b128 v[132:135], v61 offset:16656
    ds_read_b128 v[136:139], v61 offset:16672
    ds_read_b128 v[140:143], v61 offset:16688
    ds_read_b128 v[144:147], v61 offset:16704
    ds_read_b128 v[148:151], v61 offset:16720
    ds_read_b128 v[152:155], v61 offset:16736
    ds_read_b128 v[156:159], v61 offset:16752
    s_nop 0
    v_cvt_pk_bf16_f32 v232, v176, v177
    v_cvt_pk_bf16_f32 v233, v178, v179
    v_cvt_pk_bf16_f32 v234, v180, v181
    v_cvt_pk_bf16_f32 v235, v182, v183
    v_cvt_pk_bf16_f32 v236, v184, v185
    v_cvt_pk_bf16_f32 v237, v186, v187
    v_cvt_pk_bf16_f32 v238, v188, v189
    v_cvt_pk_bf16_f32 v239, v190, v191
    ds_write_b128 v62, v[224:227] offset:0
    ds_write_b128 v62, v[228:231] offset:16
    ds_write_b128 v62, v[232:235] offset:32
    ds_write_b128 v62, v[236:239] offset:48
    ds_read_b128 v[160:163], v63 offset:0
    ds_read_b128 v[164:167], v63 offset:1152
    ds_read_b128 v[168:171], v63 offset:2304
    ds_read_b128 v[172:175], v63 offset:3456
    s_waitcnt lgkmcnt(8)
    v_mfma_f32_32x32x16_bf16 v[192:207], v[64:67], v[128:131], 0
    v_mfma_f32_32x32x16_bf16 v[192:207], v[68:71], v[132:135], v[192:207]
    s_waitcnt lgkmcnt(3)
    buffer_store_dwordx4 v[160:163], v59, s[16:19], 0 offen sc1
    v_add_u32 v59, 0x1000, v59
    s_waitcnt lgkmcnt(2)
    buffer_store_dwordx4 v[164:167], v59, s[16:19], 0 offen sc1
    v_mfma_f32_32x32x16_bf16 v[192:207], v[72:75], v[136:139], v[192:207]
    v_add_u32 v59, 0x1000, v59
    s_waitcnt lgkmcnt(1)
    buffer_store_dwordx4 v[168:171], v59, s[16:19], 0 offen sc1
    v_add_u32 v59, 0x1000, v59
    s_waitcnt lgkmcnt(0)
    v_mfma_f32_32x32x16_bf16 v[192:207], v[76:79], v[140:143], v[192:207]
    buffer_store_dwordx4 v[172:175], v59, s[16:19], 0 offen sc1
    v_add_u32 v59, 0x1000, v59
    v_mfma_f32_32x32x16_bf16 v[192:207], v[80:83], v[144:147], v[192:207]
    v_mfma_f32_32x32x16_bf16 v[192:207], v[84:87], v[148:151], v[192:207]
    v_mfma_f32_32x32x16_bf16 v[192:207], v[88:91], v[152:155], v[192:207]
    v_mfma_f32_32x32x16_bf16 v[192:207], v[92:95], v[156:159], v[192:207]
    v_mfma_f32_32x32x16_bf16 v[208:223], v[96:99], v[128:131], 0
    v_mfma_f32_32x32x16_bf16 v[208:223], v[100:103], v[132:135], v[208:223]
    v_mfma_f32_32x32x16_bf16 v[208:223], v[104:107], v[136:139], v[208:223]
    s_nop 8
    v_mfma_f32_32x32x16_bf16 v[208:223], v[108:111], v[140:143], v[208:223]
    v_mul_f32 v192, s15, v192
    v_mul_f32 v193, s15, v193
    v_mul_f32 v194, s15, v194
    v_mul_f32 v195, s15, v195
    v_mul_f32 v196, s15, v196
    v_mfma_f32_32x32x16_bf16 v[208:223], v[112:115], v[144:147], v[208:223]
    v_mul_f32 v197, s15, v197
    v_mul_f32 v198, s15, v198
    v_mul_f32 v199, s15, v199
    v_mul_f32 v200, s15, v200
    v_mul_f32 v201, s15, v201
    v_mfma_f32_32x32x16_bf16 v[208:223], v[116:119], v[148:151], v[208:223]
    v_mul_f32 v202, s15, v202
    v_mul_f32 v203, s15, v203
    v_mul_f32 v204, s15, v204
    v_mul_f32 v205, s15, v205
    v_mul_f32 v206, s15, v206
    v_mfma_f32_32x32x16_bf16 v[208:223], v[120:123], v[152:155], v[208:223]
    v_mul_f32 v207, s15, v207
    v_cvt_pk_bf16_f32 v224, v192, v193
    v_cvt_pk_bf16_f32 v225, v194, v195
    v_cvt_pk_bf16_f32 v226, v196, v197
    v_cvt_pk_bf16_f32 v227, v198, v199
    v_mfma_f32_32x32x16_bf16 v[208:223], v[124:127], v[156:159], v[208:223]
    v_cvt_pk_bf16_f32 v228, v200, v201
    v_cvt_pk_bf16_f32 v229, v202, v203
    v_cvt_pk_bf16_f32 v230, v204, v205
    v_cvt_pk_bf16_f32 v231, v206, v207
    v_add_u32 v59, 0x4000, v59
    s_nop 7
    v_cvt_pk_bf16_f32 v232, v208, v209
    v_cvt_pk_bf16_f32 v233, v210, v211
    v_cvt_pk_bf16_f32 v234, v212, v213
    v_cvt_pk_bf16_f32 v235, v214, v215
    v_cvt_pk_bf16_f32 v236, v216, v217
    v_cvt_pk_bf16_f32 v237, v218, v219
    v_cvt_pk_bf16_f32 v238, v220, v221
    v_cvt_pk_bf16_f32 v239, v222, v223
    ds_write_b128 v62, v[224:227] offset:0
    ds_write_b128 v62, v[228:231] offset:16
    ds_write_b128 v62, v[232:235] offset:32
    ds_write_b128 v62, v[236:239] offset:48
    ds_read_b128 v[192:195], v63 offset:0
    ds_read_b128 v[196:199], v63 offset:1152
    ds_read_b128 v[200:203], v63 offset:2304
    ds_read_b128 v[204:207], v63 offset:3456
    s_waitcnt lgkmcnt(3)
    buffer_store_dwordx4 v[192:195], v59, s[16:19], 0 offen sc1
    v_add_u32 v59, 0x1000, v59
    s_waitcnt lgkmcnt(2)
    buffer_store_dwordx4 v[196:199], v59, s[16:19], 0 offen sc1
    v_add_u32 v59, 0x1000, v59
    s_waitcnt lgkmcnt(1)
    buffer_store_dwordx4 v[200:203], v59, s[16:19], 0 offen sc1
    v_add_u32 v59, 0x1000, v59
    s_waitcnt lgkmcnt(0)
    buffer_store_dwordx4 v[204:207], v59, s[16:19], 0 offen sc1
    v_add_u32 v59, 0x1000, v59
K1_F:
K1_END:
    s_endpgm
K1_OTHER:
    s_sub_u32 s2, s2, 196
    v_lshlrev_b32 v1, 2, v0
    v_mov_b32 v2, 0
    ds_write_b32 v1, v2
    s_mul_i32 s3, s2, 26880
    s_mul_i32 s31, s2, 55808
    s_mul_i32 s34, s2, 6720
    s_movk_i32 s35, 6720
    s_cmp_eq_u32 s2, 59
    s_cselect_b32 s35, 3520, s35
    v_cmp_gt_u32 vcc, s35, v40
    s_lshr_b32 s36, s35, 2
    s_sub_u32 s36, s36, 3
    s_waitcnt lgkmcnt(0)
    s_mov_b32 s20, s10
    s_and_b32 s21, s11, 0xffff
    s_mov_b32 s22, 0x186a00
    s_mov_b32 s23, 0x20000
    s_mov_b32 s16, s8
    s_and_b32 s17, s9, 0xffff
    s_mov_b32 s18, 0x186a00
    s_mov_b32 s19, 0x20000
    s_mov_b32 s24, s12
    s_and_b32 s25, s13, 0xffff
    s_mov_b32 s26, 0x4000000
    s_mov_b32 s27, 0x20000
    s_mov_b64 s[28:29], vcc
    s_mov_b64 exec, vcc
    s_cbranch_execz K1_PREP
    buffer_load_dwordx4 v[64:67], v40, s[20:23], s3 offen
    buffer_load_dwordx4 v[80:83], v40, s[16:19], s3 offen
    s_add_u32 s3, s3, s35
    buffer_load_dwordx4 v[68:71], v40, s[20:23], s3 offen
    buffer_load_dwordx4 v[84:87], v40, s[16:19], s3 offen
    s_add_u32 s3, s3, s35
    buffer_load_dwordx4 v[72:75], v40, s[20:23], s3 offen
    buffer_load_dwordx4 v[88:91], v40, s[16:19], s3 offen
    s_add_u32 s3, s3, s35
    buffer_load_dwordx4 v[76:79], v40, s[20:23], s3 offen
    buffer_load_dwordx4 v[92:95], v40, s[16:19], s3 offen
    s_add_u32 s3, s3, s35
    s_barrier
    v_add_u32 v3, s34, v1
    v_mov_b32 v2, 1
    s_mov_b32 s15, -49
    s_waitcnt vmcnt(7)
    v_mul_u32_u24 v96, 21400, v64
    v_lshrrev_b32 v96, 20, v96
    v_mad_i32_i24 v64, v96, s15, v64
    v_lshlrev_b32 v96, 2, v96
    ds_add_rtn_u32 v112, v96, v2
    v_mul_u32_u24 v97, 21400, v65
    v_lshrrev_b32 v97, 20, v97
    v_mad_i32_i24 v65, v97, s15, v65
    v_lshlrev_b32 v97, 2, v97
    ds_add_rtn_u32 v113, v97, v2
    v_mul_u32_u24 v98, 21400, v66
    v_lshrrev_b32 v98, 20, v98
    v_mad_i32_i24 v66, v98, s15, v66
    v_lshlrev_b32 v98, 2, v98
    ds_add_rtn_u32 v114, v98, v2
    v_mul_u32_u24 v99, 21400, v67
    v_lshrrev_b32 v99, 20, v99
    v_mad_i32_i24 v67, v99, s15, v67
    v_lshlrev_b32 v99, 2, v99
    ds_add_rtn_u32 v115, v99, v2
    s_waitcnt vmcnt(6)
    v_cmp_lt_u32 vcc, 24, v64
    v_mul_u32_u24 v22, 83, v80
    v_lshrrev_b32 v22, 16, v22
    v_cndmask_b32 v23, 0, 25, vcc
    v_sub_u32 v23, v64, v23
    v_lshl_or_b32 v128, v23, 16, v80
    v_cndmask_b32 v23, 0, 32, vcc
    v_or_b32 v22, v22, v23
    v_lshl_add_u32 v129, v22, 26, v3
    v_add_u32 v3, 1, v3
    v_cmp_lt_u32 vcc, 24, v65
    v_mul_u32_u24 v22, 83, v81
    v_lshrrev_b32 v22, 16, v22
    v_cndmask_b32 v23, 0, 25, vcc
    v_sub_u32 v23, v65, v23
    v_lshl_or_b32 v130, v23, 16, v81
    v_cndmask_b32 v23, 0, 32, vcc
    v_or_b32 v22, v22, v23
    v_lshl_add_u32 v131, v22, 26, v3
    v_add_u32 v3, 1, v3
    v_cmp_lt_u32 vcc, 24, v66
    v_mul_u32_u24 v22, 83, v82
    v_lshrrev_b32 v22, 16, v22
    v_cndmask_b32 v23, 0, 25, vcc
    v_sub_u32 v23, v66, v23
    v_lshl_or_b32 v132, v23, 16, v82
    v_cndmask_b32 v23, 0, 32, vcc
    v_or_b32 v22, v22, v23
    v_lshl_add_u32 v133, v22, 26, v3
    v_add_u32 v3, 1, v3
    v_cmp_lt_u32 vcc, 24, v67
    v_mul_u32_u24 v22, 83, v83
    v_lshrrev_b32 v22, 16, v22
    v_cndmask_b32 v23, 0, 25, vcc
    v_sub_u32 v23, v67, v23
    v_lshl_or_b32 v134, v23, 16, v83
    v_cndmask_b32 v23, 0, 32, vcc
    v_or_b32 v22, v22, v23
    v_lshl_add_u32 v135, v22, 26, v3
    v_add_u32 v3, s36, v3
    s_waitcnt vmcnt(5)
    v_mul_u32_u24 v100, 21400, v68
    v_lshrrev_b32 v100, 20, v100
    v_mad_i32_i24 v68, v100, s15, v68
    v_lshlrev_b32 v100, 2, v100
    ds_add_rtn_u32 v116, v100, v2
    v_mul_u32_u24 v101, 21400, v69
    v_lshrrev_b32 v101, 20, v101
    v_mad_i32_i24 v69, v101, s15, v69
    v_lshlrev_b32 v101, 2, v101
    ds_add_rtn_u32 v117, v101, v2
    v_mul_u32_u24 v102, 21400, v70
    v_lshrrev_b32 v102, 20, v102
    v_mad_i32_i24 v70, v102, s15, v70
    v_lshlrev_b32 v102, 2, v102
    ds_add_rtn_u32 v118, v102, v2
    v_mul_u32_u24 v103, 21400, v71
    v_lshrrev_b32 v103, 20, v103
    v_mad_i32_i24 v71, v103, s15, v71
    v_lshlrev_b32 v103, 2, v103
    ds_add_rtn_u32 v119, v103, v2
    s_waitcnt vmcnt(4)
    v_cmp_lt_u32 vcc, 24, v68
    v_mul_u32_u24 v22, 83, v84
    v_lshrrev_b32 v22, 16, v22
    v_cndmask_b32 v23, 0, 25, vcc
    v_sub_u32 v23, v68, v23
    v_lshl_or_b32 v136, v23, 16, v84
    v_cndmask_b32 v23, 0, 32, vcc
    v_or_b32 v22, v22, v23
    v_lshl_add_u32 v137, v22, 26, v3
    v_add_u32 v3, 1, v3
    v_cmp_lt_u32 vcc, 24, v69
    v_mul_u32_u24 v22, 83, v85
    v_lshrrev_b32 v22, 16, v22
    v_cndmask_b32 v23, 0, 25, vcc
    v_sub_u32 v23, v69, v23
    v_lshl_or_b32 v138, v23, 16, v85
    v_cndmask_b32 v23, 0, 32, vcc
    v_or_b32 v22, v22, v23
    v_lshl_add_u32 v139, v22, 26, v3
    v_add_u32 v3, 1, v3
    v_cmp_lt_u32 vcc, 24, v70
    v_mul_u32_u24 v22, 83, v86
    v_lshrrev_b32 v22, 16, v22
    v_cndmask_b32 v23, 0, 25, vcc
    v_sub_u32 v23, v70, v23
    v_lshl_or_b32 v140, v23, 16, v86
    v_cndmask_b32 v23, 0, 32, vcc
    v_or_b32 v22, v22, v23
    v_lshl_add_u32 v141, v22, 26, v3
    v_add_u32 v3, 1, v3
    v_cmp_lt_u32 vcc, 24, v71
    v_mul_u32_u24 v22, 83, v87
    v_lshrrev_b32 v22, 16, v22
    v_cndmask_b32 v23, 0, 25, vcc
    v_sub_u32 v23, v71, v23
    v_lshl_or_b32 v142, v23, 16, v87
    v_cndmask_b32 v23, 0, 32, vcc
    v_or_b32 v22, v22, v23
    v_lshl_add_u32 v143, v22, 26, v3
    v_add_u32 v3, s36, v3
    s_waitcnt vmcnt(3)
    v_mul_u32_u24 v104, 21400, v72
    v_lshrrev_b32 v104, 20, v104
    v_mad_i32_i24 v72, v104, s15, v72
    v_lshlrev_b32 v104, 2, v104
    ds_add_rtn_u32 v120, v104, v2
    v_mul_u32_u24 v105, 21400, v73
    v_lshrrev_b32 v105, 20, v105
    v_mad_i32_i24 v73, v105, s15, v73
    v_lshlrev_b32 v105, 2, v105
    ds_add_rtn_u32 v121, v105, v2
    v_mul_u32_u24 v106, 21400, v74
    v_lshrrev_b32 v106, 20, v106
    v_mad_i32_i24 v74, v106, s15, v74
    v_lshlrev_b32 v106, 2, v106
    ds_add_rtn_u32 v122, v106, v2
    v_mul_u32_u24 v107, 21400, v75
    v_lshrrev_b32 v107, 20, v107
    v_mad_i32_i24 v75, v107, s15, v75
    v_lshlrev_b32 v107, 2, v107
    ds_add_rtn_u32 v123, v107, v2
    s_waitcnt vmcnt(2)
    v_cmp_lt_u32 vcc, 24, v72
    v_mul_u32_u24 v22, 83, v88
    v_lshrrev_b32 v22, 16, v22
    v_cndmask_b32 v23, 0, 25, vcc
    v_sub_u32 v23, v72, v23
    v_lshl_or_b32 v144, v23, 16, v88
    v_cndmask_b32 v23, 0, 32, vcc
    v_or_b32 v22, v22, v23
    v_lshl_add_u32 v145, v22, 26, v3
    v_add_u32 v3, 1, v3
    v_cmp_lt_u32 vcc, 24, v73
    v_mul_u32_u24 v22, 83, v89
    v_lshrrev_b32 v22, 16, v22
    v_cndmask_b32 v23, 0, 25, vcc
    v_sub_u32 v23, v73, v23
    v_lshl_or_b32 v146, v23, 16, v89
    v_cndmask_b32 v23, 0, 32, vcc
    v_or_b32 v22, v22, v23
    v_lshl_add_u32 v147, v22, 26, v3
    v_add_u32 v3, 1, v3
    v_cmp_lt_u32 vcc, 24, v74
    v_mul_u32_u24 v22, 83, v90
    v_lshrrev_b32 v22, 16, v22
    v_cndmask_b32 v23, 0, 25, vcc
    v_sub_u32 v23, v74, v23
    v_lshl_or_b32 v148, v23, 16, v90
    v_cndmask_b32 v23, 0, 32, vcc
    v_or_b32 v22, v22, v23
    v_lshl_add_u32 v149, v22, 26, v3
    v_add_u32 v3, 1, v3
    v_cmp_lt_u32 vcc, 24, v75
    v_mul_u32_u24 v22, 83, v91
    v_lshrrev_b32 v22, 16, v22
    v_cndmask_b32 v23, 0, 25, vcc
    v_sub_u32 v23, v75, v23
    v_lshl_or_b32 v150, v23, 16, v91
    v_cndmask_b32 v23, 0, 32, vcc
    v_or_b32 v22, v22, v23
    v_lshl_add_u32 v151, v22, 26, v3
    v_add_u32 v3, s36, v3
    s_waitcnt vmcnt(1)
    v_mul_u32_u24 v108, 21400, v76
    v_lshrrev_b32 v108, 20, v108
    v_mad_i32_i24 v76, v108, s15, v76
    v_lshlrev_b32 v108, 2, v108
    ds_add_rtn_u32 v124, v108, v2
    v_mul_u32_u24 v109, 21400, v77
    v_lshrrev_b32 v109, 20, v109
    v_mad_i32_i24 v77, v109, s15, v77
    v_lshlrev_b32 v109, 2, v109
    ds_add_rtn_u32 v125, v109, v2
    v_mul_u32_u24 v110, 21400, v78
    v_lshrrev_b32 v110, 20, v110
    v_mad_i32_i24 v78, v110, s15, v78
    v_lshlrev_b32 v110, 2, v110
    ds_add_rtn_u32 v126, v110, v2
    v_mul_u32_u24 v111, 21400, v79
    v_lshrrev_b32 v111, 20, v111
    v_mad_i32_i24 v79, v111, s15, v79
    v_lshlrev_b32 v111, 2, v111
    ds_add_rtn_u32 v127, v111, v2
    s_waitcnt vmcnt(0)
K1_B:
    s_mov_b64 exec, -1
    v_lshlrev_b32 v20, 5, v20
    s_waitcnt lgkmcnt(0)
    s_barrier
    ds_read_b128 v[24:27], v20
    ds_read_b128 v[28:31], v20 offset:16
    v_cmp_lt_u32 vcc, 24, v76
    v_mul_u32_u24 v22, 83, v92
    v_lshrrev_b32 v22, 16, v22
    v_cndmask_b32 v23, 0, 25, vcc
    v_sub_u32 v23, v76, v23
    v_lshl_or_b32 v152, v23, 16, v92
    v_cndmask_b32 v23, 0, 32, vcc
    v_or_b32 v22, v22, v23
    v_lshl_add_u32 v153, v22, 26, v3
    v_add_u32 v3, 1, v3
    v_cmp_lt_u32 vcc, 24, v77
    v_mul_u32_u24 v22, 83, v93
    v_lshrrev_b32 v22, 16, v22
    v_cndmask_b32 v23, 0, 25, vcc
    v_sub_u32 v23, v77, v23
    v_lshl_or_b32 v154, v23, 16, v93
    v_cndmask_b32 v23, 0, 32, vcc
    v_or_b32 v22, v22, v23
    v_lshl_add_u32 v155, v22, 26, v3
    v_add_u32 v3, 1, v3
    s_waitcnt lgkmcnt(0)
    v_mov_b32 v33, v24
    v_add_u32 v34, v33, v25
    v_add_u32 v35, v34, v26
    v_add_u32 v36, v35, v27
    v_add_u32 v37, v36, v28
    v_add_u32 v38, v37, v29
    v_add_u32 v39, v38, v30
    v_add_u32 v21, v39, v31
    v_mov_b32 v22, v21
    s_nop 1
    v_add_u32_dpp v21, v21, v21 row_shr:1 row_mask:0xf bank_mask:0xf bound_ctrl:0
    s_nop 1
    v_add_u32_dpp v21, v21, v21 row_shr:2 row_mask:0xf bank_mask:0xf bound_ctrl:0
    s_nop 1
    v_add_u32_dpp v21, v21, v21 row_shr:4 row_mask:0xf bank_mask:0xf bound_ctrl:0
    s_nop 1
    v_add_u32_dpp v21, v21, v21 row_shr:8 row_mask:0xf bank_mask:0xf bound_ctrl:0
    s_nop 1
    v_add_u32_dpp v21, v21, v21 row_bcast:15 row_mask:0xa bank_mask:0xf
    s_nop 1
    v_add_u32_dpp v21, v21, v21 row_bcast:31 row_mask:0xc bank_mask:0xf
    v_sub_u32 v32, v21, v22
    v_add_u32 v33, v32, v33
    v_add_u32 v34, v32, v34
    v_add_u32 v35, v32, v35
    v_add_u32 v36, v32, v36
    v_add_u32 v37, v32, v37
    v_add_u32 v38, v32, v38
    v_add_u32 v39, v32, v39
    ds_write_b128 v20, v[32:35] offset:2048
    ds_write_b128 v20, v[36:39] offset:2064
    s_mov_b64 exec, s[28:29]
    ds_read_b32 v96, v96 offset:2048
    ds_read_b32 v97, v97 offset:2048
    ds_read_b32 v98, v98 offset:2048
    ds_read_b32 v99, v99 offset:2048
    ds_read_b32 v100, v100 offset:2048
    ds_read_b32 v101, v101 offset:2048
    ds_read_b32 v102, v102 offset:2048
    ds_read_b32 v103, v103 offset:2048
    ds_read_b32 v104, v104 offset:2048
    ds_read_b32 v105, v105 offset:2048
    ds_read_b32 v106, v106 offset:2048
    ds_read_b32 v107, v107 offset:2048
    ds_read_b32 v108, v108 offset:2048
    ds_read_b32 v109, v109 offset:2048
    ds_read_b32 v110, v110 offset:2048
    ds_read_b32 v111, v111 offset:2048
    v_cmp_lt_u32 vcc, 24, v78
    v_mul_u32_u24 v22, 83, v94
    v_lshrrev_b32 v22, 16, v22
    v_cndmask_b32 v23, 0, 25, vcc
    v_sub_u32 v23, v78, v23
    v_lshl_or_b32 v156, v23, 16, v94
    v_cndmask_b32 v23, 0, 32, vcc
    v_or_b32 v22, v22, v23
    v_lshl_add_u32 v157, v22, 26, v3
    v_add_u32 v3, 1, v3
    v_cmp_lt_u32 vcc, 24, v79
    v_mul_u32_u24 v22, 83, v95
    v_lshrrev_b32 v22, 16, v22
    v_cndmask_b32 v23, 0, 25, vcc
    v_sub_u32 v23, v79, v23
    v_lshl_or_b32 v158, v23, 16, v95
    v_cndmask_b32 v23, 0, 32, vcc
    v_or_b32 v22, v22, v23
    v_lshl_add_u32 v159, v22, 26, v3
    v_add_u32 v3, s36, v3
    s_waitcnt lgkmcnt(12)
    v_add_lshl_u32 v64, v96, v112, 3
    ds_write_b64 v64, v[128:129] offset:6144
    v_add_lshl_u32 v65, v97, v113, 3
    ds_write_b64 v65, v[130:131] offset:6144
    v_add_lshl_u32 v66, v98, v114, 3
    ds_write_b64 v66, v[132:133] offset:6144
    v_add_lshl_u32 v67, v99, v115, 3
    ds_write_b64 v67, v[134:135] offset:6144
    s_waitcnt lgkmcnt(12)
    v_add_lshl_u32 v68, v100, v116, 3
    ds_write_b64 v68, v[136:137] offset:6144
    v_add_lshl_u32 v69, v101, v117, 3
    ds_write_b64 v69, v[138:139] offset:6144
    v_add_lshl_u32 v70, v102, v118, 3
    ds_write_b64 v70, v[140:141] offset:6144
    v_add_lshl_u32 v71, v103, v119, 3
    ds_write_b64 v71, v[142:143] offset:6144
    s_waitcnt lgkmcnt(12)
    v_add_lshl_u32 v72, v104, v120, 3
    ds_write_b64 v72, v[144:145] offset:6144
    v_add_lshl_u32 v73, v105, v121, 3
    ds_write_b64 v73, v[146:147] offset:6144
    v_add_lshl_u32 v74, v106, v122, 3
    ds_write_b64 v74, v[148:149] offset:6144
    v_add_lshl_u32 v75, v107, v123, 3
    ds_write_b64 v75, v[150:151] offset:6144
    s_waitcnt lgkmcnt(12)
    v_add_lshl_u32 v76, v108, v124, 3
    ds_write_b64 v76, v[152:153] offset:6144
    v_add_lshl_u32 v77, v109, v125, 3
    ds_write_b64 v77, v[154:155] offset:6144
    v_add_lshl_u32 v78, v110, v126, 3
    ds_write_b64 v78, v[156:157] offset:6144
    v_add_lshl_u32 v79, v111, v127, 3
    ds_write_b64 v79, v[158:159] offset:6144
    s_mov_b64 exec, -1
    s_cmp_lg_u32 s33, 7
    s_cbranch_scc1 K1_O2
    s_lshr_b32 s34, s31, 3
    s_add_u32 s34, s34, 256
    v_lshl_add_u32 v24, v24, 19, v32
    v_add_u32 v24, s34, v24
    v_lshl_add_u32 v25, v25, 19, v33
    v_add_u32 v25, s34, v25
    v_lshl_add_u32 v26, v26, 19, v34
    v_add_u32 v26, s34, v26
    v_lshl_add_u32 v27, v27, 19, v35
    v_add_u32 v27, s34, v27
    v_lshl_add_u32 v28, v28, 19, v36
    v_add_u32 v28, s34, v28
    v_lshl_add_u32 v29, v29, 19, v37
    v_add_u32 v29, s34, v29
    v_lshl_add_u32 v30, v30, 19, v38
    v_add_u32 v30, s34, v30
    v_lshl_add_u32 v31, v31, 19, v39
    v_add_u32 v31, s34, v31
    ds_write_b128 v20, v[24:27] offset:4096
    ds_write_b128 v20, v[28:31] offset:4112
K1_O2:
    v_cmp_gt_u32 vcc, 416, v0
    v_add_u32 v41, 0x9000, v40
    s_waitcnt lgkmcnt(0)
    s_barrier
    ds_read_b128 v[64:67], v40 offset:4096
    ds_read_b128 v[68:71], v40 offset:12288
    ds_read_b128 v[72:75], v40 offset:20480
    ds_read_b128 v[76:79], v40 offset:28672
    ds_read_b128 v[80:83], v41 offset:0
    ds_read_b128 v[84:87], v41 offset:8192
    ds_read_b128 v[88:91], v41 offset:16384
    s_waitcnt lgkmcnt(6)
    buffer_store_dwordx4 v[64:67], v40, s[24:27], s31 offen sc1
    s_add_u32 s31, s31, 8192
    s_waitcnt lgkmcnt(5)
    buffer_store_dwordx4 v[68:71], v40, s[24:27], s31 offen sc1
    s_add_u32 s31, s31, 8192
    s_waitcnt lgkmcnt(4)
    buffer_store_dwordx4 v[72:75], v40, s[24:27], s31 offen sc1
    s_add_u32 s31, s31, 8192
    s_waitcnt lgkmcnt(3)
    buffer_store_dwordx4 v[76:79], v40, s[24:27], s31 offen sc1
    s_add_u32 s31, s31, 8192
    s_waitcnt lgkmcnt(2)
    buffer_store_dwordx4 v[80:83], v40, s[24:27], s31 offen sc1
    s_add_u32 s31, s31, 8192
    s_waitcnt lgkmcnt(1)
    buffer_store_dwordx4 v[84:87], v40, s[24:27], s31 offen sc1
    s_add_u32 s31, s31, 8192
    s_and_saveexec_b64 s[28:29], vcc
    s_cbranch_execz K1_SE
    s_waitcnt lgkmcnt(0)
    buffer_store_dwordx4 v[88:91], v40, s[24:27], s31 offen sc1
    s_add_u32 s31, s31, 8192
K1_SE:
    s_endpgm
K1_PREP:
    s_barrier
    s_cmp_lg_u32 s33, 7
    s_cbranch_scc1 K1_B
    s_mov_b64 exec, -1
    v_and_b32 v4, 3, v0
    v_bfe_u32 v5, v0, 3, 2
    v_lshl_or_b32 v4, v5, 2, v4
    v_bfe_u32 v5, v0, 2, 1
    v_lshl_or_b32 v4, v5, 4, v4
    v_lshlrev_b32 v42, 4, v20
    s_mov_b32 s70, s2
    s_add_u32 s71, s2, 60
    s_cmp_lt_u32 s71, 68
    s_cselect_b32 s71, s71, s2
    s_lshr_b32 s14, s70, 5
    s_cmp_eq_u32 s14, 1
    s_cselect_b32 s64, s46, s40
    s_cselect_b32 s65, s47, s41
    s_mov_b32 s66, 32768
    s_bfe_u32 s50, s70, 0x20003
    s_and_b32 s51, s70, 7
    s_mov_b32 s32, 14
    s_cmp_eq_u32 s14, 2
    s_cselect_b32 s64, s44, s64
    s_cselect_b32 s65, s45, s65
    s_cselect_b32 s66, 4096, s66
    s_cselect_b32 s68, 0xbfb8aa3b, 1.0
    s_cselect_b32 s50, s51, s50
    s_cselect_b32 s51, 0, s51
    s_cselect_b32 s32, 11, s32
    s_and_b32 s65, s65, 0xffff
    s_mov_b32 s67, 0x20000
    s_lshl_b32 s50, s50, 6
    s_lshl_b32 s51, s51, 11
    s_add_u32 s50, s50, s51
    v_lshlrev_b32 v5, s32, v57
    v_lshl_add_u32 v5, v4, 1, v5
    v_add_u32 v5, s50, v5
    buffer_load_ushort v64, v5, s[64:67], 0 offen offset:0
    buffer_load_ushort v65, v5, s[64:67], 0 offen offset:256
    buffer_load_ushort v66, v5, s[64:67], 0 offen offset:512
    buffer_load_ushort v67, v5, s[64:67], 0 offen offset:768
    buffer_load_ushort v68, v5, s[64:67], 0 offen offset:1024
    buffer_load_ushort v69, v5, s[64:67], 0 offen offset:1280
    buffer_load_ushort v70, v5, s[64:67], 0 offen offset:1536
    buffer_load_ushort v71, v5, s[64:67], 0 offen offset:1792
    s_lshr_b32 s14, s71, 5
    s_cmp_eq_u32 s14, 1
    s_cselect_b32 s64, s46, s40
    s_cselect_b32 s65, s47, s41
    s_mov_b32 s66, 32768
    s_bfe_u32 s50, s71, 0x20003
    s_and_b32 s51, s71, 7
    s_mov_b32 s32, 14
    s_cmp_eq_u32 s14, 2
    s_cselect_b32 s64, s44, s64
    s_cselect_b32 s65, s45, s65
    s_cselect_b32 s66, 4096, s66
    s_cselect_b32 s69, 0xbfb8aa3b, 1.0
    s_cselect_b32 s50, s51, s50
    s_cselect_b32 s51, 0, s51
    s_cselect_b32 s32, 11, s32
    s_and_b32 s65, s65, 0xffff
    s_mov_b32 s67, 0x20000
    s_lshl_b32 s50, s50, 6
    s_lshl_b32 s51, s51, 11
    s_add_u32 s50, s50, s51
    v_lshlrev_b32 v5, s32, v57
    v_lshl_add_u32 v5, v4, 1, v5
    v_add_u32 v5, s50, v5
    buffer_load_ushort v72, v5, s[64:67], 0 offen offset:0
    buffer_load_ushort v73, v5, s[64:67], 0 offen offset:256
    buffer_load_ushort v74, v5, s[64:67], 0 offen offset:512
    buffer_load_ushort v75, v5, s[64:67], 0 offen offset:768
    buffer_load_ushort v76, v5, s[64:67], 0 offen offset:1024
    buffer_load_ushort v77, v5, s[64:67], 0 offen offset:1280
    buffer_load_ushort v78, v5, s[64:67], 0 offen offset:1536
    buffer_load_ushort v79, v5, s[64:67], 0 offen offset:1792
    s_lshl_b32 s14, s70, 10
    s_add_u32 s14, s14, 0x3c0000
    s_waitcnt vmcnt(8)
    v_lshlrev_b32 v64, 16, v64
    v_mul_f32 v64, s68, v64
    v_lshlrev_b32 v65, 16, v65
    v_mul_f32 v65, s68, v65
    v_lshlrev_b32 v66, 16, v66
    v_mul_f32 v66, s68, v66
    v_lshlrev_b32 v67, 16, v67
    v_mul_f32 v67, s68, v67
    v_lshlrev_b32 v68, 16, v68
    v_mul_f32 v68, s68, v68
    v_lshlrev_b32 v69, 16, v69
    v_mul_f32 v69, s68, v69
    v_lshlrev_b32 v70, 16, v70
    v_mul_f32 v70, s68, v70
    v_lshlrev_b32 v71, 16, v71
    v_mul_f32 v71, s68, v71
    v_cvt_pk_bf16_f32 v8, v64, v65
    v_cvt_pk_bf16_f32 v9, v66, v67
    v_cvt_pk_bf16_f32 v10, v68, v69
    v_cvt_pk_bf16_f32 v11, v70, v71
    buffer_store_dwordx4 v[8:11], v42, s[24:27], s14 offen sc1
    s_lshl_b32 s14, s71, 10
    s_add_u32 s14, s14, 0x3c0000
    s_waitcnt vmcnt(1)
    v_lshlrev_b32 v72, 16, v72
    v_mul_f32 v72, s69, v72
    v_lshlrev_b32 v73, 16, v73
    v_mul_f32 v73, s69, v73
    v_lshlrev_b32 v74, 16, v74
    v_mul_f32 v74, s69, v74
    v_lshlrev_b32 v75, 16, v75
    v_mul_f32 v75, s69, v75
    v_lshlrev_b32 v76, 16, v76
    v_mul_f32 v76, s69, v76
    v_lshlrev_b32 v77, 16, v77
    v_mul_f32 v77, s69, v77
    v_lshlrev_b32 v78, 16, v78
    v_mul_f32 v78, s69, v78
    v_lshlrev_b32 v79, 16, v79
    v_mul_f32 v79, s69, v79
    v_cvt_pk_bf16_f32 v12, v72, v73
    v_cvt_pk_bf16_f32 v13, v74, v75
    v_cvt_pk_bf16_f32 v14, v76, v77
    v_cvt_pk_bf16_f32 v15, v78, v79
    buffer_store_dwordx4 v[12:15], v42, s[24:27], s14 offen sc1
    s_branch K1_B
.globl gmain_kernel
.p2align 8
.type gmain_kernel,@function
gmain_kernel:
    s_load_dwordx2 s[50:51], s[0:1], 88
    s_load_dwordx4 s[4:7], s[0:1], 0
    s_load_dwordx2 s[48:49], s[0:1], 72
    s_setprio 3
    v_lshrrev_b32 v164, 6, v0
    s_and_b32 s3, s2, 7
    s_lshl_b32 s3, s3, 6
    s_bfe_u32 s35, s2, 0x50003
    s_lshl1_add_u32 s3, s35, s3
    v_readfirstlane_b32 s24, v164
    s_lshr_b32 s35, s2, 8
    s_add_u32 s3, s3, s35
    s_cmp_ge_u32 s2, 512
    s_cbranch_scc1 K2_END
    s_cmp_ge_u32 s3, 511
    s_cbranch_scc1 K2_END
    v_lshrrev_b32 v165, 4, v0
    s_lshl_b32 s88, s3, 2
    v_mul_u32_u24 v165, 55808, v165
    v_add_u32 v165, s88, v165
    v_add_u32 v166, 0xda000, v165
    v_add_u32 v167, 0x1b4000, v165
    v_add_u32 v168, 0x28e000, v165
    s_mul_i32 s25, s3, 49
    v_and_b32 v23, 63, v0
    v_lshlrev_b32 v23, 4, v23
    s_mul_i32 s26, s24, 4160
    s_add_u32 s26, s26, 29008
    s_lshl_b32 s52, s24, 13
    s_add_u32 s52, s52, 0x3c0000
    s_mov_b32 s40, 0x358637bd
    s_mov_b32 s41, s40
    s_mov_b32 s38, 0xbfb8aa3b
    s_mov_b32 s32, 1
    s_mov_b32 s31, 64
    s_cmp_ge_u32 s2, 256
    s_cselect_b32 s30, 4, 0
    v_bfe_u32 v196, v0, 0, 2
    v_mul_u32_u24 v196, 0x8001, v196
    v_and_b32 v196, 0x10001, v196
    v_mul_u32_u24 v196, 0x3f80, v196
    v_bfe_u32 v197, v0, 2, 2
    v_mul_u32_u24 v197, 0x8001, v197
    v_and_b32 v197, 0x10001, v197
    v_mul_u32_u24 v197, 0x3f80, v197
    v_bfe_u32 v198, v0, 4, 2
    v_mul_u32_u24 v198, 0x8001, v198
    v_and_b32 v198, 0x10001, v198
    v_mul_u32_u24 v198, 0x3f80, v198
    v_bfe_u32 v199, v0, 6, 2
    v_mul_u32_u24 v199, 0x8001, v199
    v_and_b32 v199, 0x10001, v199
    v_mul_u32_u24 v199, 0x3f80, v199
    v_lshlrev_b32 v200, 4, v0
    v_bfe_u32 v201, v0, 4, 1
    v_mul_u32_u24 v201, 48, v201
    v_add_u32 v200, v200, v201
    v_bfe_u32 v201, v0, 5, 1
    v_mul_u32_u24 v201, 80, v201
    v_add_u32 v200, v200, v201
    v_bfe_u32 v201, v0, 6, 1
    v_mul_u32_u24 v201, 160, v201
    v_add_u32 v200, v200, v201
    v_bfe_u32 v201, v0, 7, 1
    v_mul_u32_u24 v201, 352, v201
    v_add_u32 v200, v200, v201
    ds_write_b128 v200, v[196:199] offset:0
    v_bfe_u32 v196, v0, 1, 4
    v_bfe_u32 v197, v0, 5, 1
    v_lshl_add_u32 v197, v197, 3, 1
    v_sub_u32 v196, v196, v197
    v_and_b32 v197, 1, v0
    v_lshlrev_b32 v197, 2, v197
    v_sub_u32 v196, v196, v197
    v_cmp_gt_u32 vcc, 4, v196
    v_mov_b32 v202, 0x3f80
    v_mov_b32 v203, 0
    v_lshlrev_b32 v196, 4, v196
    v_cndmask_b32 v202, 0, v202, vcc
    v_lshlrev_b64 v[202:203], v196, v[202:203]
    v_lshrrev_b32 v196, 1, v23
    ds_write_b64 v196, v[202:203] offset:4736
    v_mov_b64 v[132:133], s[40:41]
    v_mov_b64 v[134:135], s[40:41]
    v_mov_b64 v[136:137], s[40:41]
    v_mov_b64 v[138:139], s[40:41]
    v_mov_b64 v[140:141], s[40:41]
    v_mov_b64 v[142:143], s[40:41]
    v_mov_b64 v[144:145], s[40:41]
    v_mov_b64 v[146:147], s[40:41]
    v_mov_b64 v[148:149], 0
    v_mov_b64 v[150:151], 0
    v_mov_b64 v[152:153], 0
    v_mov_b64 v[154:155], 0
    v_mov_b64 v[156:157], 0
    v_mov_b64 v[158:159], 0
    v_mov_b64 v[160:161], 0
    v_mov_b64 v[162:163], 0
    s_waitcnt lgkmcnt(0)
    s_mov_b32 s16, s50
    s_and_b32 s17, s51, 0xffff
    s_mov_b32 s18, 0x4000000
    s_mov_b32 s19, 0x20000
    s_mov_b32 s18, 0x331800
    buffer_load_dword v28, v165, s[16:19], 0 offen
    buffer_load_dword v29, v166, s[16:19], 0 offen
    buffer_load_dword v30, v167, s[16:19], 0 offen
    buffer_load_dword v31, v168, s[16:19], 0 offen
    s_mov_b32 s18, 0x4000000
    s_mov_b32 s8, s4
    s_and_b32 s9, s5, 0xffff
    s_or_b32 s9, s9, 0x1000000
    s_mov_b32 s10, 0x61a8
    s_mov_b32 s11, 0x20000
    s_mov_b32 s12, s6
    s_and_b32 s13, s7, 0xffff
    s_or_b32 s13, s13, 0x200000
    s_mov_b32 s14, 0x61a80
    s_mov_b32 s15, 0x20000
    s_mov_b32 s20, s48
    s_and_b32 s21, s49, 0xffff
    s_or_b32 s21, s21, 0x1000000
    s_mov_b32 s22, 0x61a8
    s_mov_b32 s23, 0x20000
    s_add_u32 s50, s50, 0x400000
    s_addc_u32 s51, s51, 0
    s_mov_b32 s96, s50
    s_and_b32 s97, s51, 0xffff
    s_or_b32 s97, s97, 0x2000000
    s_mov_b32 s98, 0x61a8
    s_mov_b32 s99, 0x20000
ROUND:
    v_lshlrev_b32 v175, 4, v0
    v_mov_b32 v164, 0
    v_mov_b32 v165, 0
    v_mov_b32 v166, 0
    v_mov_b32 v167, 0
    ds_write_b128 v175, v[164:167] offset:13696
    ds_write_b128 v175, v[164:167] offset:16720
    v_mov_b32 v168, 0x19ffff
    v_mov_b32 v169, 0x7ffff
    v_mov_b32 v170, 0x19ffff
    v_mov_b32 v171, 0x7ffff
    ds_write_b128 v175, v[168:171] offset:5504
    ds_write_b128 v175, v[168:171] offset:9600
    v_and_b32 v180, 1, v0
    v_bfe_u32 v181, v0, 2, 1
    v_bfe_u32 v182, v0, 3, 1
    v_bfe_u32 v183, v0, 4, 1
    v_bfe_u32 v184, v0, 5, 1
    v_and_b32 v172, 15, v0
    v_lshlrev_b32 v172, 1, v172
    v_mov_b32 v173, 0x7ffffff0
    s_mov_b32 s36, 0x7ffff
    v_and_b32 v176, 15, v0
    v_lshlrev_b32 v177, 3, v183
    v_xor_b32 v27, v176, v177
    v_lshlrev_b32 v27, 4, v27
    s_lshr_b32 s35, s24, 1
    s_lshl_b32 s35, s35, 4
    s_and_b32 s54, s24, 1
    s_lshl2_add_u32 s35, s54, s35
    v_lshl_add_u32 v26, v184, 3, v183
    v_add_u32 v26, s35, v26
    v_mov_b32 v35, 0xffff
    s_waitcnt vmcnt(0)
    v_lshrrev_b32 v168, 19, v28
    v_cmp_lt_u32 vcc, v172, v168
    v_and_b32 v164, s36, v28
    v_add_lshl_u32 v164, v164, v172, 3
    v_cndmask_b32 v174, v173, v164, vcc
    buffer_load_dwordx4 v[36:39], v174, s[16:19], 0 offen
    v_lshrrev_b32 v169, 19, v29
    v_cmp_lt_u32 vcc, v172, v169
    v_and_b32 v165, s36, v29
    v_add_lshl_u32 v165, v165, v172, 3
    v_cndmask_b32 v174, v173, v165, vcc
    buffer_load_dwordx4 v[40:43], v174, s[16:19], 0 offen
    v_lshrrev_b32 v170, 19, v30
    v_cmp_lt_u32 vcc, v172, v170
    v_and_b32 v166, s36, v30
    v_add_lshl_u32 v166, v166, v172, 3
    v_cndmask_b32 v174, v173, v166, vcc
    buffer_load_dwordx4 v[44:47], v174, s[16:19], 0 offen
    v_lshrrev_b32 v171, 19, v31
    v_cmp_lt_u32 vcc, v172, v171
    v_and_b32 v167, s36, v31
    v_add_lshl_u32 v167, v167, v172, 3
    v_cndmask_b32 v174, v173, v167, vcc
    buffer_load_dwordx4 v[48:51], v174, s[16:19], 0 offen
    v_max3_u32 v174, v168, v169, v170
    v_max_u32 v174, v174, v171
    v_cmp_lt_u32 vcc, 32, v174
    s_cbranch_vccz REC_DONE
    buffer_load_dwordx4 v[52:55], v164, s[16:19], 0 offen offset:256
    buffer_load_dwordx4 v[56:59], v165, s[16:19], 0 offen offset:256
    buffer_load_dwordx4 v[60:63], v166, s[16:19], 0 offen offset:256
    buffer_load_dwordx4 v[64:67], v167, s[16:19], 0 offen offset:256
REC_DONE:
    s_waitcnt lgkmcnt(0)
    s_barrier
    v_and_b32 v178, 0x13, v0
    v_lshl_or_b32 v178, v181, 3, v178
    v_lshl_or_b32 v178, v182, 2, v178
    v_lshrrev_b32 v176, 3, v178
    v_lshlrev_b32 v1, 7, v178
    v_lshl_add_u32 v1, v176, 4, v1
    v_bfe_u32 v177, v0, 1, 1
    v_xor_b32 v176, v177, v184
    v_lshl_add_u32 v1, v176, 6, v1
    v_add_u32 v1, s26, v1
    v_and_b32 v176, 7, v0
    v_lshlrev_b32 v179, 2, v183
    v_xor_b32 v179, v179, v176
    s_lshl_b32 s35, s24, 7
    v_lshl_add_u32 v3, v179, 4, s35
    v_mov_b32 v5, v3
    v_mov_b32 v7, v3
    v_mov_b32 v9, v3
    v_and_b32 v19, 0x38, v0
    v_add_u32 v19, 5504, v19
    v_lshl_or_b32 v179, v183, 1, v181
    v_mul_u32_u24 v179, 4160, v179
    v_mul_u32_u24 v177, 1040, v177
    v_lshl_or_b32 v185, v182, 1, v180
    v_lshl_add_u32 v179, v185, 8, v179
    v_add3_u32 v179, v179, v177, 0
    v_add_u32 v179, 62288, v179
    v_xor_b32 v177, v184, v180
    v_lshl_add_u32 v24, v177, 7, v179
    v_lshlrev_b32 v11, 4, v177
    v_bfe_u32 v177, v0, 7, 1
    v_xor_b32 v177, v177, v180
    v_lshl_add_u32 v25, v177, 7, v179
    v_and_b32 v177, 0x60, v0
    v_add_u32 v25, v25, v177
    s_lshl_b32 s35, s54, 12
    s_lshr_b32 s36, s24, 1
    s_lshl_b32 s36, s36, 8
    s_add_u32 s35, s35, s36
    s_add_u32 s35, s35, 5508
    v_bfe_u32 v20, v0, 1, 5
    v_lshl_add_u32 v20, v20, 3, s35
    s_lshl_b32 s27, s24, 10
    s_add_u32 s27, s27, 20816
    v_lshl_add_u32 v17, v178, 3, v184
    v_add_u32 v17, 5506, v17
    v_xor_b32 v15, v183, v184
    v_lshlrev_b32 v15, 4, v15
    v_lshl_add_u32 v15, v178, 5, v15
    v_add_u32 v15, 20816, v15
    v_add_u32 v16, 4096, v15
    v_xor_b32 v16, v16, v15
    v_and_b32 v177, 31, v0
    v_min_u32 v177, 25, v177
    v_mul_u32_u24 v18, 264, v177
    v_lshl_add_u32 v18, v184, 2, v18
    v_add_u32 v18, 13696, v18
    v_lshrrev_b32 v34, 5, v0
    v_lshlrev_b32 v34, 4, v34
    v_lshl_add_u32 v34, v182, 2, v34
    v_lshlrev_b32 v33, v176, 16
    v_lshlrev_b32 v177, 3, v176
    v_add_u32 v177, -32, v177
    s_mov_b32 s36, 0x160a0503
    v_cmp_lt_u32 vcc, 3, v176
    v_bfe_u32 v177, s36, v177, 8
    s_nop 0
    v_cndmask_b32 v177, 0, v177, vcc
    v_lshl_add_u32 v33, v177, 4, v33
    v_lshlrev_b32 v177, 4, v183
    v_lshlrev_b32 v33, v177, v33
    v_and_b32 v176, 3, v0
    v_lshl_add_u32 v179, v183, 2, v176
    v_lshlrev_b32 v176, v179, 16
    v_lshlrev_b32 v177, 3, v179
    v_add_u32 v177, -32, v177
    s_mov_b32 s36, 0x160a0503
    v_cmp_lt_u32 vcc, 3, v179
    v_bfe_u32 v177, s36, v177, 8
    s_nop 0
    v_cndmask_b32 v177, 0, v177, vcc
    v_lshl_add_u32 v176, v177, 4, v176
    v_cmp_eq_u32 vcc, v182, v184
    v_lshlrev_b32 v177, 4, v181
    s_nop 0
    v_cndmask_b32 v176, 0, v176, vcc
    v_lshlrev_b32 v32, v177, v176
REMASK:
    v_and_b32 v164, 15, v0
    v_lshlrev_b32 v164, 1, v164
    v_mov_b32 v166, 0
    v_lshrrev_b32 v165, 19, v28
    v_max_u32 v166, v166, v165
    v_min_u32 v165, s31, v165
    v_sub_u32 v165, v165, v164
    v_cmp_lt_i32 s[56:57], 0, v165
    v_cmp_lt_i32 s[58:59], 1, v165
    v_cmp_lt_i32 s[72:73], 32, v165
    v_cmp_lt_i32 s[74:75], 33, v165
    v_lshrrev_b32 v165, 19, v29
    v_max_u32 v166, v166, v165
    v_min_u32 v165, s31, v165
    v_sub_u32 v165, v165, v164
    v_cmp_lt_i32 s[60:61], 0, v165
    v_cmp_lt_i32 s[62:63], 1, v165
    v_cmp_lt_i32 s[76:77], 32, v165
    v_cmp_lt_i32 s[78:79], 33, v165
    v_lshrrev_b32 v165, 19, v30
    v_max_u32 v166, v166, v165
    v_min_u32 v165, s31, v165
    v_sub_u32 v165, v165, v164
    v_cmp_lt_i32 s[64:65], 0, v165
    v_cmp_lt_i32 s[66:67], 1, v165
    v_cmp_lt_i32 s[80:81], 32, v165
    v_cmp_lt_i32 s[82:83], 33, v165
    v_lshrrev_b32 v165, 19, v31
    v_max_u32 v166, v166, v165
    v_min_u32 v165, s31, v165
    v_sub_u32 v165, v165, v164
    v_cmp_lt_i32 s[68:69], 0, v165
    v_cmp_lt_i32 s[70:71], 1, v165
    v_cmp_lt_i32 s[84:85], 32, v165
    v_cmp_lt_i32 s[86:87], 33, v165
    v_cmp_lt_u32 vcc, s31, v166
    s_or_b64 s[44:45], s[72:73], s[76:77]
    s_or_b64 s[42:43], s[80:81], s[84:85]
    s_or_b64 s[44:45], s[44:45], s[42:43]
    v_mov_b32 v165, 20556
    s_mov_b64 exec, vcc
    ds_write_b32 v165, v165
    s_mov_b64 exec, -1
    v_mov_b32 v164, 8
    v_lshrrev_b32 v165, 2, v23
    s_waitcnt vmcnt(0)
    v_lshrrev_b32 v84, 24, v37
    v_lshrrev_b32 v85, 24, v39
    v_lshrrev_b32 v86, 24, v41
    v_lshrrev_b32 v87, 24, v43
    v_lshrrev_b32 v88, 24, v45
    v_lshrrev_b32 v89, 24, v47
    v_lshrrev_b32 v90, 24, v49
    v_lshrrev_b32 v91, 24, v51
    s_mov_b64 exec, s[56:57]
    ds_add_rtn_u32 v68, v84, v164 offset:20560
    s_mov_b64 exec, s[58:59]
    ds_add_rtn_u32 v69, v85, v164 offset:20560
    s_mov_b64 exec, s[60:61]
    ds_add_rtn_u32 v70, v86, v164 offset:20560
    s_mov_b64 exec, s[62:63]
    ds_add_rtn_u32 v71, v87, v164 offset:20560
    s_mov_b64 exec, s[64:65]
    ds_add_rtn_u32 v72, v88, v164 offset:20560
    s_mov_b64 exec, s[66:67]
    ds_add_rtn_u32 v73, v89, v164 offset:20560
    s_mov_b64 exec, s[68:69]
    ds_add_rtn_u32 v74, v90, v164 offset:20560
    s_mov_b64 exec, s[70:71]
    ds_add_rtn_u32 v75, v91, v164 offset:20560
    s_cmp_eq_u64 s[44:45], 0
    s_cbranch_scc1 P1_DONE
    s_mov_b64 exec, -1
    v_lshrrev_b32 v92, 24, v53
    v_lshrrev_b32 v93, 24, v55
    v_lshrrev_b32 v94, 24, v57
    v_lshrrev_b32 v95, 24, v59
    v_lshrrev_b32 v96, 24, v61
    v_lshrrev_b32 v97, 24, v63
    v_lshrrev_b32 v98, 24, v65
    v_lshrrev_b32 v99, 24, v67
    s_mov_b64 exec, s[72:73]
    ds_add_rtn_u32 v76, v92, v164 offset:20560
    s_mov_b64 exec, s[74:75]
    ds_add_rtn_u32 v77, v93, v164 offset:20560
    s_mov_b64 exec, s[76:77]
    ds_add_rtn_u32 v78, v94, v164 offset:20560
    s_mov_b64 exec, s[78:79]
    ds_add_rtn_u32 v79, v95, v164 offset:20560
    s_mov_b64 exec, s[80:81]
    ds_add_rtn_u32 v80, v96, v164 offset:20560
    s_mov_b64 exec, s[82:83]
    ds_add_rtn_u32 v81, v97, v164 offset:20560
    s_mov_b64 exec, s[84:85]
    ds_add_rtn_u32 v82, v98, v164 offset:20560
    s_mov_b64 exec, s[86:87]
    ds_add_rtn_u32 v83, v99, v164 offset:20560
P1_DONE:
    s_mov_b64 exec, -1
    s_cmp_eq_u32 s32, 0
    s_cbranch_scc1 NOW_p1
    s_add_u32 s29, s26, 33280
    v_mov_b32 v197, v27
    s_add_u32 m0, s29, 0
    v_cmp_gt_u32 vcc, 25, v26
    s_add_u32 s35, s25, 0
    v_add_u32 v196, s35, v26
    v_cndmask_b32 v196, v35, v196, vcc
    buffer_load_dwordx4 v[196:197], s[8:11], 0 idxen offen lds
    s_add_u32 m0, s29, 1040
    v_cmp_gt_u32 vcc, 23, v26
    s_add_u32 s35, s25, 2
    v_add_u32 v196, s35, v26
    v_cndmask_b32 v196, v35, v196, vcc
    buffer_load_dwordx4 v[196:197], s[8:11], 0 idxen offen lds
    s_add_u32 m0, s29, 2080
    v_cmp_gt_u32 vcc, 24, v26
    s_add_u32 s35, s25, 25
    v_add_u32 v196, s35, v26
    v_cndmask_b32 v196, v35, v196, vcc
    buffer_load_dwordx4 v[196:197], s[8:11], 0 idxen offen lds
    s_add_u32 m0, s29, 3120
    v_cmp_gt_u32 vcc, 22, v26
    s_add_u32 s35, s25, 27
    v_add_u32 v196, s35, v26
    v_cndmask_b32 v196, v35, v196, vcc
    buffer_load_dwordx4 v[196:197], s[8:11], 0 idxen offen lds
    s_add_u32 s35, s52, 0x0
    buffer_load_dwordx4 v[100:103], v23, s[16:19], s35 offen offset:0
    buffer_load_dwordx4 v[104:107], v23, s[16:19], s35 offen offset:1024
    buffer_load_dwordx4 v[108:111], v23, s[16:19], s35 offen offset:2048
    buffer_load_dwordx4 v[112:115], v23, s[16:19], s35 offen offset:3072
    s_add_u32 s35, s52, 0x1000
    buffer_load_dwordx4 v[116:119], v23, s[16:19], s35 offen offset:0
    buffer_load_dwordx4 v[120:123], v23, s[16:19], s35 offen offset:1024
    buffer_load_dwordx4 v[124:127], v23, s[16:19], s35 offen offset:2048
    buffer_load_dwordx4 v[128:131], v23, s[16:19], s35 offen offset:3072
    s_lshl_b32 s35, s24, 10
    s_add_u32 s35, s35, 0x3d0000
    buffer_load_dwordx4 v[192:195], v23, s[16:19], s35 offen
NOW_p1:
    s_waitcnt lgkmcnt(0)
    s_barrier
    ds_read_b32 v166, v165 offset:20560
    ds_read_b32 v168, v165 offset:20556
    v_lshlrev_b32 v169, 12, v184
    s_waitcnt lgkmcnt(1)
    v_sub_u32 v167, v169, v166
    v_add_u32_dpp v166, v166, v166 row_shr:1 row_mask:0xf bank_mask:0xf bound_ctrl:0
    s_nop 1
    v_add_u32_dpp v166, v166, v166 row_shr:2 row_mask:0xf bank_mask:0xf bound_ctrl:0
    s_nop 1
    v_add_u32_dpp v166, v166, v166 row_shr:4 row_mask:0xf bank_mask:0xf bound_ctrl:0
    s_nop 1
    v_add_u32_dpp v166, v166, v166 row_shr:8 row_mask:0xf bank_mask:0xf bound_ctrl:0
    s_nop 1
    v_add_u32_dpp v166, v166, v166 row_bcast:15 row_mask:0xa bank_mask:0xf
    v_add_u32 v167, v166, v167
    v_readlane_b32 s4, v166, 31
    v_readlane_b32 s5, v166, 63
    s_add_u32 s29, s4, 255
    s_lshr_b32 s29, s29, 8
    s_lshl1_add_u32 s29, s29, -1
    s_add_u32 s28, s5, 255
    s_lshr_b32 s28, s28, 8
    s_lshl_b32 s28, s28, 1
    s_max_i32 s29, s29, s28
    s_max_i32 s29, s29, 2
    s_add_u32 s6, s29, 1
    s_lshr_b32 s6, s6, 1
    s_lshl_b32 s6, s6, 8
    s_sub_u32 s6, s6, s4
    s_lshr_b32 s7, s29, 1
    s_lshl_b32 s7, s7, 8
    s_sub_u32 s7, s7, s5
    s_sub_u32 s7, s7, s6
    v_mad_i32_i24 v167, v184, s7, v167
    v_add_u32 v167, s6, v167
    ds_write_b32 v165, v167 offset:5248
    ds_read_b32 v84, v84 offset:5248
    ds_read_b32 v85, v85 offset:5248
    ds_read_b32 v86, v86 offset:5248
    ds_read_b32 v87, v87 offset:5248
    ds_read_b32 v88, v88 offset:5248
    ds_read_b32 v89, v89 offset:5248
    ds_read_b32 v90, v90 offset:5248
    ds_read_b32 v91, v91 offset:5248
    s_cmp_le_u32 s29, 32
    s_cbranch_scc0 TOOBIG
    s_waitcnt lgkmcnt(4)
    v_add_u32 v68, v68, v84
    v_add_u32 v69, v69, v85
    v_add_u32 v70, v70, v86
    v_add_u32 v71, v71, v87
    s_waitcnt lgkmcnt(0)
    v_add_u32 v72, v72, v88
    v_add_u32 v73, v73, v89
    v_add_u32 v74, v74, v90
    v_add_u32 v75, v75, v91
    s_mov_b64 exec, s[56:57]
    ds_write_b64 v68, v[36:37] offset:5504
    s_mov_b64 exec, s[58:59]
    ds_write_b64 v69, v[38:39] offset:5504
    s_mov_b64 exec, s[60:61]
    ds_write_b64 v70, v[40:41] offset:5504
    s_mov_b64 exec, s[62:63]
    ds_write_b64 v71, v[42:43] offset:5504
    s_mov_b64 exec, s[64:65]
    ds_write_b64 v72, v[44:45] offset:5504
    s_mov_b64 exec, s[66:67]
    ds_write_b64 v73, v[46:47] offset:5504
    s_mov_b64 exec, s[68:69]
    ds_write_b64 v74, v[48:49] offset:5504
    s_mov_b64 exec, s[70:71]
    ds_write_b64 v75, v[50:51] offset:5504
    s_cmp_eq_u64 s[44:45], 0
    s_cbranch_scc1 P2_DONE
    s_mov_b64 exec, -1
    ds_read_b32 v92, v92 offset:5248
    ds_read_b32 v93, v93 offset:5248
    ds_read_b32 v94, v94 offset:5248
    ds_read_b32 v95, v95 offset:5248
    ds_read_b32 v96, v96 offset:5248
    ds_read_b32 v97, v97 offset:5248
    ds_read_b32 v98, v98 offset:5248
    ds_read_b32 v99, v99 offset:5248
    s_waitcnt lgkmcnt(4)
    v_add_u32 v76, v76, v92
    v_add_u32 v77, v77, v93
    v_add_u32 v78, v78, v94
    v_add_u32 v79, v79, v95
    s_waitcnt lgkmcnt(0)
    v_add_u32 v80, v80, v96
    v_add_u32 v81, v81, v97
    v_add_u32 v82, v82, v98
    v_add_u32 v83, v83, v99
    s_mov_b64 exec, s[72:73]
    ds_write_b64 v76, v[52:53] offset:5504
    s_mov_b64 exec, s[74:75]
    ds_write_b64 v77, v[54:55] offset:5504
    s_mov_b64 exec, s[76:77]
    ds_write_b64 v78, v[56:57] offset:5504
    s_mov_b64 exec, s[78:79]
    ds_write_b64 v79, v[58:59] offset:5504
    s_mov_b64 exec, s[80:81]
    ds_write_b64 v80, v[60:61] offset:5504
    s_mov_b64 exec, s[82:83]
    ds_write_b64 v81, v[62:63] offset:5504
    s_mov_b64 exec, s[84:85]
    ds_write_b64 v82, v[64:65] offset:5504
    s_mov_b64 exec, s[86:87]
    ds_write_b64 v83, v[66:67] offset:5504
P2_DONE:
    s_mov_b64 exec, -1
    v_readlane_b32 s33, v168, 0
    s_mov_b32 m0, s27
    s_waitcnt vmcnt(9) lgkmcnt(0)
    s_barrier
    ds_read_b32 v10, v20
    ds_read_u16 v2, v19 offset:0
    ds_read_u16 v4, v19 offset:64
    ds_read_u16 v6, v19 offset:128
    ds_read_u16 v8, v19 offset:192
    v_lshlrev_b32 v173, 3, v0
    s_waitcnt lgkmcnt(4)
    v_and_b32 v10, 0x7ffff, v10
    buffer_load_dwordx4 v[10:11], s[12:15], 0 idxen offen lds
    s_add_u32 m0, s26, 0
    s_waitcnt lgkmcnt(3)
    buffer_load_dwordx4 v[2:3], s[96:99], 0 idxen offen lds
    ds_read_u16 v2, v19 offset:4096
    s_add_u32 m0, s26, 1040
    s_waitcnt lgkmcnt(3)
    buffer_load_dwordx4 v[4:5], s[96:99], 0 idxen offen lds
    ds_read_u16 v4, v19 offset:4160
    s_add_u32 m0, s26, 2080
    s_waitcnt lgkmcnt(3)
    buffer_load_dwordx4 v[6:7], s[96:99], 0 idxen offen lds
    ds_read_u16 v6, v19 offset:4224
    s_add_u32 m0, s26, 3120
    s_waitcnt lgkmcnt(3)
    buffer_load_dwordx4 v[8:9], s[96:99], 0 idxen offen lds
    ds_read_u16 v8, v19 offset:4288
    ds_read_u8 v176, v173 offset:5506
    ds_read_u8 v177, v173 offset:7554
    ds_read_u8 v178, v173 offset:9602
    ds_read_u8 v179, v173 offset:11650
    ds_read_b32 v10, v20 offset:512
    s_cmp_eq_u32 s32, 1
    s_cbranch_scc1 G1
    s_waitcnt lgkmcnt(0)
    s_movk_i32 s54, 264
    v_cmp_gt_u32 vcc, 25, v176
    v_mad_u32_u24 v164, v176, s54, v34
    v_lshrrev_b32 v166, 1, v176
    v_bfi_b32 v166, 3, v176, v166
    v_lshl_add_u32 v166, v166, 4, 16
    v_and_b32 v167, 4, v176
    v_lshlrev_b32 v167, 1, v167
    v_lshlrev_b32 v166, v167, v166
    v_cndmask_b32 v166, 0, v166, vcc
    ds_write_b16 v173, v166 offset:5506
    v_cndmask_b32 v165, 0, v33, vcc
    ds_add_u32 v164, v165 offset:13696
    v_cmp_gt_u32 vcc, 25, v177
    v_mad_u32_u24 v164, v177, s54, v34
    v_lshrrev_b32 v166, 1, v177
    v_bfi_b32 v166, 3, v177, v166
    v_lshl_add_u32 v166, v166, 4, 16
    v_and_b32 v167, 4, v177
    v_lshlrev_b32 v167, 1, v167
    v_lshlrev_b32 v166, v167, v166
    v_cndmask_b32 v166, 0, v166, vcc
    ds_write_b16 v173, v166 offset:7554
    v_cndmask_b32 v165, 0, v33, vcc
    ds_add_u32 v164, v165 offset:13824
    v_cmp_gt_u32 vcc, 25, v178
    v_mad_u32_u24 v164, v178, s54, v34
    v_lshrrev_b32 v166, 1, v178
    v_bfi_b32 v166, 3, v178, v166
    v_lshl_add_u32 v166, v166, 4, 16
    v_and_b32 v167, 4, v178
    v_lshlrev_b32 v167, 1, v167
    v_lshlrev_b32 v166, v167, v166
    v_cndmask_b32 v166, 0, v166, vcc
    ds_write_b16 v173, v166 offset:9602
    v_cndmask_b32 v165, 0, v33, vcc
    ds_add_u32 v164, v165 offset:13704
    v_cmp_gt_u32 vcc, 25, v179
    v_mad_u32_u24 v164, v179, s54, v34
    v_lshrrev_b32 v166, 1, v179
    v_bfi_b32 v166, 3, v179, v166
    v_lshl_add_u32 v166, v166, 4, 16
    v_and_b32 v167, 4, v179
    v_lshlrev_b32 v167, 1, v167
    v_lshlrev_b32 v166, v167, v166
    v_cndmask_b32 v166, 0, v166, vcc
    ds_write_b16 v173, v166 offset:11650
    v_cndmask_b32 v165, 0, v33, vcc
    ds_add_u32 v164, v165 offset:13832
    s_sub_u32 s28, s29, 2
    s_add_u32 s39, s27, 4096
    s_xor_b32 s39, s39, s27
    s_add_u32 s27, s27, 4096
    v_add_u32 v20, 512, v20
    s_branch G1D
G1:
    ds_read_b128 v[36:39], v24 offset:0
    ds_read_b128 v[40:43], v24 offset:16
    ds_read_b128 v[44:47], v24 offset:32
    ds_read_b128 v[48:51], v24 offset:48
    ds_read_b128 v[52:55], v24 offset:64
    ds_read_b128 v[56:59], v24 offset:80
    ds_read_b128 v[60:63], v24 offset:96
    ds_read_b128 v[64:67], v24 offset:112
    s_waitcnt lgkmcnt(8)
    ds_read_b128 v[68:71], v24 offset:2080
    ds_read_b128 v[72:75], v24 offset:2096
    ds_read_b128 v[76:79], v24 offset:2112
    ds_read_b128 v[80:83], v24 offset:2128
    ds_read_b128 v[84:87], v24 offset:2144
    ds_read_b128 v[88:91], v24 offset:2160
    ds_read_b128 v[92:95], v24 offset:2176
    ds_read_b128 v[96:99], v24 offset:2192
    s_waitcnt vmcnt(6) lgkmcnt(8)
    v_mfma_f32_32x32x16_bf16 v[228:243], v[36:39], v[100:103], 0
    s_movk_i32 s54, 264
    v_cmp_gt_u32 vcc, 25, v176
    v_mad_u32_u24 v164, v176, s54, v34
    v_lshrrev_b32 v166, 1, v176
    v_bfi_b32 v166, 3, v176, v166
    v_mfma_f32_32x32x16_bf16 v[228:243], v[40:43], v[104:107], v[228:243]
    v_lshl_add_u32 v166, v166, 4, 16
    v_and_b32 v167, 4, v176
    v_lshlrev_b32 v167, 1, v167
    v_lshlrev_b32 v166, v167, v166
    v_cndmask_b32 v166, 0, v166, vcc
    v_mfma_f32_32x32x16_bf16 v[228:243], v[44:47], v[108:111], v[228:243]
    ds_write_b16 v173, v166 offset:5506
    v_cndmask_b32 v165, 0, v33, vcc
    ds_add_u32 v164, v165 offset:13696
    v_cmp_gt_u32 vcc, 25, v177
    v_mad_u32_u24 v164, v177, s54, v34
    v_mfma_f32_32x32x16_bf16 v[228:243], v[48:51], v[112:115], v[228:243]
    v_lshrrev_b32 v166, 1, v177
    v_bfi_b32 v166, 3, v177, v166
    v_lshl_add_u32 v166, v166, 4, 16
    v_and_b32 v167, 4, v177
    v_lshlrev_b32 v167, 1, v167
    v_mfma_f32_32x32x16_bf16 v[228:243], v[52:55], v[116:119], v[228:243]
    v_lshlrev_b32 v166, v167, v166
    v_cndmask_b32 v166, 0, v166, vcc
    ds_write_b16 v173, v166 offset:7554
    v_cndmask_b32 v165, 0, v33, vcc
    ds_add_u32 v164, v165 offset:13824
    v_mfma_f32_32x32x16_bf16 v[228:243], v[56:59], v[120:123], v[228:243]
    v_cmp_gt_u32 vcc, 25, v178
    v_mad_u32_u24 v164, v178, s54, v34
    v_lshrrev_b32 v166, 1, v178
    v_bfi_b32 v166, 3, v178, v166
    v_lshl_add_u32 v166, v166, 4, 16
    v_mfma_f32_32x32x16_bf16 v[228:243], v[60:63], v[124:127], v[228:243]
    v_and_b32 v167, 4, v178
    v_lshlrev_b32 v167, 1, v167
    v_lshlrev_b32 v166, v167, v166
    v_cndmask_b32 v166, 0, v166, vcc
    ds_write_b16 v173, v166 offset:9602
    v_mfma_f32_32x32x16_bf16 v[228:243], v[64:67], v[128:131], v[228:243]
    v_cndmask_b32 v165, 0, v33, vcc
    ds_add_u32 v164, v165 offset:13704
    v_cmp_gt_u32 vcc, 25, v179
    v_mad_u32_u24 v164, v179, s54, v34
    v_lshrrev_b32 v166, 1, v179
    s_waitcnt lgkmcnt(6)
    v_mfma_f32_32x32x16_bf16 v[36:51], v[68:71], v[100:103], 0
    v_bfi_b32 v166, 3, v179, v166
    v_lshl_add_u32 v166, v166, 4, 16
    v_and_b32 v167, 4, v179
    v_lshlrev_b32 v167, 1, v167
    v_lshlrev_b32 v166, v167, v166
    v_mfma_f32_32x32x16_bf16 v[36:51], v[72:75], v[104:107], v[36:51]
    v_cndmask_b32 v166, 0, v166, vcc
    ds_write_b16 v173, v166 offset:11650
    v_cndmask_b32 v165, 0, v33, vcc
    ds_add_u32 v164, v165 offset:13832
    s_sub_u32 s28, s29, 2
    v_mfma_f32_32x32x16_bf16 v[36:51], v[76:79], v[108:111], v[36:51]
    s_add_u32 s39, s27, 4096
    s_xor_b32 s39, s39, s27
    s_add_u32 s27, s27, 4096
    v_add_u32 v20, 512, v20
    v_mul_f32 v228, s38, v228
    v_mfma_f32_32x32x16_bf16 v[36:51], v[80:83], v[112:115], v[36:51]
    v_mul_f32 v229, s38, v229
    v_mul_f32 v230, s38, v230
    v_mul_f32 v231, s38, v231
    v_mul_f32 v232, s38, v232
    v_mul_f32 v233, s38, v233
    v_mfma_f32_32x32x16_bf16 v[36:51], v[84:87], v[116:119], v[36:51]
    v_mul_f32 v234, s38, v234
    v_mul_f32 v235, s38, v235
    v_mul_f32 v236, s38, v236
    v_mul_f32 v237, s38, v237
    v_mul_f32 v238, s38, v238
    v_mfma_f32_32x32x16_bf16 v[36:51], v[88:91], v[120:123], v[36:51]
    v_mul_f32 v239, s38, v239
    v_mul_f32 v240, s38, v240
    v_mul_f32 v241, s38, v241
    v_mul_f32 v242, s38, v242
    v_mul_f32 v243, s38, v243
    v_mfma_f32_32x32x16_bf16 v[36:51], v[92:95], v[124:127], v[36:51]
    v_cvt_pk_bf16_f32 v204, v228, v229
    v_cvt_pk_bf16_f32 v205, v230, v231
    v_cvt_pk_bf16_f32 v206, v232, v233
    v_cvt_pk_bf16_f32 v207, v234, v235
    v_cvt_pk_bf16_f32 v208, v236, v237
    v_mfma_f32_32x32x16_bf16 v[36:51], v[96:99], v[128:131], v[36:51]
    v_cvt_pk_bf16_f32 v209, v238, v239
    v_cvt_pk_bf16_f32 v210, v240, v241
    v_cvt_pk_bf16_f32 v211, v242, v243
    v_mov_b64 v[100:101], s[40:41]
    v_mov_b64 v[102:103], s[40:41]
    v_mov_b64 v[104:105], s[40:41]
    v_mov_b64 v[106:107], s[40:41]
    v_mov_b64 v[108:109], s[40:41]
    v_mov_b64 v[110:111], s[40:41]
    v_mov_b64 v[112:113], s[40:41]
    v_mov_b64 v[114:115], s[40:41]
    v_mov_b64 v[116:117], 0
    v_mov_b64 v[118:119], 0
    v_mov_b64 v[120:121], 0
    v_mov_b64 v[122:123], 0
    v_mov_b64 v[124:125], 0
    v_mov_b64 v[126:127], 0
    v_mov_b64 v[128:129], 0
    v_mov_b64 v[130:131], 0
    v_mul_f32 v36, s38, v36
    v_mul_f32 v37, s38, v37
    v_mul_f32 v38, s38, v38
    v_mul_f32 v39, s38, v39
    v_mul_f32 v40, s38, v40
    v_mul_f32 v41, s38, v41
    v_mul_f32 v42, s38, v42
    v_mul_f32 v43, s38, v43
    v_mul_f32 v44, s38, v44
    v_mul_f32 v45, s38, v45
    v_mul_f32 v46, s38, v46
    v_mul_f32 v47, s38, v47
    v_mul_f32 v48, s38, v48
    v_mul_f32 v49, s38, v49
    v_mul_f32 v50, s38, v50
    v_mul_f32 v51, s38, v51
    v_cvt_pk_bf16_f32 v212, v36, v37
    v_cvt_pk_bf16_f32 v213, v38, v39
    v_cvt_pk_bf16_f32 v214, v40, v41
    v_cvt_pk_bf16_f32 v215, v42, v43
    v_cvt_pk_bf16_f32 v216, v44, v45
    v_cvt_pk_bf16_f32 v217, v46, v47
    v_cvt_pk_bf16_f32 v218, v48, v49
    v_cvt_pk_bf16_f32 v219, v50, v51
G1D:
    v_and_b32 v12, 0xffff, v32
    v_lshrrev_b32 v13, 16, v32
    s_add_u32 m0, s26, 16640
    s_waitcnt lgkmcnt(3)
    buffer_load_dwordx4 v[2:3], s[96:99], 0 idxen offen lds
    ds_read_u16 v2, v19 offset:256
    s_add_u32 m0, s26, 17680
    s_waitcnt lgkmcnt(3)
    buffer_load_dwordx4 v[4:5], s[96:99], 0 idxen offen lds
    ds_read_u16 v4, v19 offset:320
    s_add_u32 m0, s26, 18720
    s_waitcnt lgkmcnt(3)
    buffer_load_dwordx4 v[6:7], s[96:99], 0 idxen offen lds
    ds_read_u16 v6, v19 offset:384
    s_add_u32 m0, s26, 19760
    s_waitcnt lgkmcnt(3)
    buffer_load_dwordx4 v[8:9], s[96:99], 0 idxen offen lds
    ds_read_u16 v8, v19 offset:448
    s_waitcnt vmcnt(4) lgkmcnt(0)
    s_barrier
    ds_read_b128 v[220:223], v12
    ds_read_b128 v[224:227], v13
    ds_read_u8 v21, v17
    ds_read_b128 v[180:183], v15
    ds_read_b128 v[164:167], v1 offset:0
    ds_read_b128 v[168:171], v1 offset:16
    ds_read_b128 v[172:175], v1 offset:32
    ds_read_b128 v[176:179], v1 offset:48
    s_setprio 3
    s_waitcnt lgkmcnt(0)
    s_add_u32 m0, s26, 0
    s_nop 0
    buffer_load_dwordx4 v[2:3], s[96:99], 0 idxen offen lds
    ds_read_u16 v2, v19 offset:4352
    ds_read_b128 v[184:187], v21 offset:4736
    ds_read_b128 v[188:191], v21 offset:4992
    ds_read_u8 v21, v17 offset:4096
    s_add_u32 m0, s26, 1040
    s_nop 0
    buffer_load_dwordx4 v[4:5], s[96:99], 0 idxen offen lds
    ds_read_u16 v4, v19 offset:4416
    v_mfma_f32_32x32x16_bf16 v[36:51], v[164:167], v[220:223], 0
    ds_read_b128 v[196:199], v12
    s_add_u32 m0, s26, 2080
    s_nop 0
    buffer_load_dwordx4 v[6:7], s[96:99], 0 idxen offen lds
    ds_read_u16 v6, v19 offset:4480
    v_mfma_f32_32x32x16_bf16 v[36:51], v[168:171], v[224:227], v[36:51]
    ds_read_b128 v[200:203], v13
    s_add_u32 m0, s26, 3120
    s_nop 0
    buffer_load_dwordx4 v[8:9], s[96:99], 0 idxen offen lds
    ds_read_u16 v8, v19 offset:4544
    v_mfma_f32_32x32x16_bf16 v[36:51], v[180:183], v[192:195], v[36:51]
    ds_read_b128 v[180:183], v15 offset:1024
    ds_read_u16 v12, v18 offset:0
    ds_read_u16 v13, v18 offset:2
    v_mfma_f32_32x32x16_bf16 v[52:67], v[172:175], v[220:223], 0
    ds_read_b32 v10, v20
    v_mfma_f32_32x32x16_bf16 v[52:67], v[176:179], v[224:227], v[52:67]
    s_waitcnt lgkmcnt(10)
    v_mfma_f32_32x32x16_bf16 v[36:51], v[184:187], v[204:207], v[36:51]
    s_waitcnt vmcnt(4)
    v_mfma_f32_32x32x16_bf16 v[36:51], v[188:191], v[208:211], v[36:51]
    ds_read_b128 v[164:167], v1 offset:16640
    ds_read_b128 v[168:171], v1 offset:16656
    ds_read_b128 v[172:175], v1 offset:16672
    ds_read_b128 v[176:179], v1 offset:16688
    s_nop 7
    s_waitcnt lgkmcnt(0)
    s_add_u32 m0, s26, 16640
    v_exp_f32 v36, v36
    buffer_load_dwordx4 v[2:3], s[96:99], 0 idxen offen lds
    v_exp_f32 v37, v37
    ds_read_u16 v2, v19 offset:512
    v_exp_f32 v38, v38
    v_exp_f32 v39, v39
    v_add_f32 v36, 1.0, v36
    v_add_f32 v37, 1.0, v37
    ds_read_b128 v[184:187], v21 offset:4736
    v_rcp_f32 v36, v36
    ds_read_b128 v[188:191], v21 offset:4992
    v_rcp_f32 v37, v37
    v_exp_f32 v40, v40
    v_exp_f32 v41, v41
    v_add_f32 v38, 1.0, v38
    ds_read_u8 v21, v17 offset:256
    v_add_f32 v39, 1.0, v39
    s_add_u32 m0, s26, 17680
    v_rcp_f32 v38, v38
    buffer_load_dwordx4 v[4:5], s[96:99], 0 idxen offen lds
    v_rcp_f32 v39, v39
    ds_read_u16 v4, v19 offset:576
    v_mul_f32 v52, v36, v52
    v_mul_f32 v53, v37, v53
    v_exp_f32 v42, v42
    v_exp_f32 v43, v43
    v_add_f32 v40, 1.0, v40
    v_add_f32 v41, 1.0, v41
    v_rcp_f32 v40, v40
    v_rcp_f32 v41, v41
    v_mul_f32 v54, v38, v54
    v_mul_f32 v55, v39, v55
    v_cvt_pk_bf16_f32 v36, v36, v37
    s_branch ENT1
TOOBIG:
    s_mov_b32 s31, 8
    v_mov_b32 v164, 0
    s_waitcnt lgkmcnt(0)
    s_barrier
    ds_write_b32 v165, v164 offset:20560
    s_waitcnt lgkmcnt(0)
    s_barrier
    s_branch REMASK
LOOP:
    s_waitcnt lgkmcnt(0)
    v_mfma_f32_32x32x16_bf16 v[100:115], v[36:39], v[196:199], v[100:115]
    s_add_u32 m0, s26, 0
    v_exp_f32 v68, v68
    buffer_load_dwordx4 v[2:3], s[96:99], 0 idxen offen lds
    v_exp_f32 v69, v69
    ds_read_u16 v2, v19 offset:4352
    v_exp_f32 v70, v70
    v_exp_f32 v71, v71
    v_add_f32 v68, 1.0, v68
    v_add_f32 v69, 1.0, v69
    v_mfma_f32_32x32x16_bf16 v[116:131], v[52:55], v[196:199], v[116:131]
    ds_read_b128 v[184:187], v21 offset:4736
    v_rcp_f32 v68, v68
    ds_read_b128 v[188:191], v21 offset:4992
    v_rcp_f32 v69, v69
    v_exp_f32 v72, v72
    v_exp_f32 v73, v73
    v_add_f32 v70, 1.0, v70
    v_mfma_f32_32x32x16_bf16 v[100:115], v[40:43], v[200:203], v[100:115]
    ds_read_u8 v21, v17 offset:4096
    v_add_f32 v71, 1.0, v71
    s_add_u32 m0, s26, 1040
    v_rcp_f32 v70, v70
    buffer_load_dwordx4 v[4:5], s[96:99], 0 idxen offen lds
    v_rcp_f32 v71, v71
    ds_read_u16 v4, v19 offset:4416
    v_mul_f32 v84, v68, v84
    v_mul_f32 v85, v69, v85
    v_exp_f32 v74, v74
    v_mfma_f32_32x32x16_bf16 v[116:131], v[56:59], v[200:203], v[116:131]
    v_exp_f32 v75, v75
    v_add_f32 v72, 1.0, v72
    v_add_f32 v73, 1.0, v73
    v_rcp_f32 v72, v72
    v_rcp_f32 v73, v73
    v_mul_f32 v86, v70, v86
    v_mul_f32 v87, v71, v87
    v_cvt_pk_bf16_f32 v68, v68, v69
    s_sub_u32 s28, s28, 1
    s_cbranch_scc1 TAIL0
ENT0:
    v_mfma_f32_32x32x16_bf16 v[36:51], v[164:167], v[220:223], 0
    ds_read_b128 v[196:199], v12
    v_cvt_pk_bf16_f32 v84, v84, v85
    s_add_u32 m0, s26, 2080
    v_exp_f32 v76, v76
    buffer_load_dwordx4 v[6:7], s[96:99], 0 idxen offen lds
    v_exp_f32 v77, v77
    ds_read_u16 v6, v19 offset:4480
    v_add_f32 v74, 1.0, v74
    v_add_f32 v75, 1.0, v75
    v_rcp_f32 v74, v74
    v_mfma_f32_32x32x16_bf16 v[36:51], v[168:171], v[224:227], v[36:51]
    ds_read_b128 v[200:203], v13
    v_rcp_f32 v75, v75
    s_add_u32 m0, s26, 3120
    v_mul_f32 v88, v72, v88
    buffer_load_dwordx4 v[8:9], s[96:99], 0 idxen offen lds
    v_mul_f32 v89, v73, v89
    ds_read_u16 v8, v19 offset:4544
    v_cvt_pk_bf16_f32 v69, v70, v71
    v_cvt_pk_bf16_f32 v85, v86, v87
    v_exp_f32 v78, v78
    v_exp_f32 v79, v79
    v_mfma_f32_32x32x16_bf16 v[36:51], v[180:183], v[192:195], v[36:51]
    ds_read_b128 v[180:183], v15 offset:1024
    v_add_f32 v76, 1.0, v76
    ds_read_u16 v12, v18 offset:0
    v_add_f32 v77, 1.0, v77
    ds_read_u16 v13, v18 offset:2
    v_rcp_f32 v76, v76
    v_rcp_f32 v77, v77
    v_mul_f32 v90, v74, v90
    v_mul_f32 v91, v75, v91
    v_cvt_pk_bf16_f32 v70, v72, v73
    v_cvt_pk_bf16_f32 v86, v88, v89
    v_mfma_f32_32x32x16_bf16 v[52:67], v[172:175], v[220:223], 0
    ds_read_b32 v10, v20
    v_exp_f32 v80, v80
    v_exp_f32 v81, v81
    v_add_f32 v78, 1.0, v78
    v_add_f32 v79, 1.0, v79
    v_rcp_f32 v78, v78
    v_rcp_f32 v79, v79
    v_mfma_f32_32x32x16_bf16 v[52:67], v[176:179], v[224:227], v[52:67]
    v_mul_f32 v92, v76, v92
    v_mul_f32 v93, v77, v93
    v_cvt_pk_bf16_f32 v71, v74, v75
    v_cvt_pk_bf16_f32 v87, v90, v91
    v_exp_f32 v82, v82
    v_exp_f32 v83, v83
    v_add_f32 v80, 1.0, v80
    s_waitcnt lgkmcnt(10)
    v_mfma_f32_32x32x16_bf16 v[36:51], v[184:187], v[204:207], v[36:51]
    v_add_f32 v81, 1.0, v81
    v_rcp_f32 v80, v80
    v_rcp_f32 v81, v81
    v_mul_f32 v94, v78, v94
    v_mul_f32 v95, v79, v95
    v_cvt_pk_bf16_f32 v72, v76, v77
    v_cvt_pk_bf16_f32 v88, v92, v93
    v_add_f32 v82, 1.0, v82
    s_waitcnt vmcnt(4)
    v_mfma_f32_32x32x16_bf16 v[36:51], v[188:191], v[208:211], v[36:51]
    ds_read_b128 v[164:167], v1 offset:16640
    v_add_f32 v83, 1.0, v83
    ds_read_b128 v[168:171], v1 offset:16656
    v_rcp_f32 v82, v82
    ds_read_b128 v[172:175], v1 offset:16672
    v_rcp_f32 v83, v83
    ds_read_b128 v[176:179], v1 offset:16688
    v_mul_f32 v96, v80, v96
    v_mul_f32 v97, v81, v97
    v_cvt_pk_bf16_f32 v73, v78, v79
    v_cvt_pk_bf16_f32 v89, v94, v95
    v_mul_f32 v98, v82, v98
    v_mul_f32 v99, v83, v99
    v_cvt_pk_bf16_f32 v74, v80, v81
    v_cvt_pk_bf16_f32 v90, v96, v97
    v_cvt_pk_bf16_f32 v75, v82, v83
    v_cvt_pk_bf16_f32 v91, v98, v99
    s_waitcnt lgkmcnt(0)
    v_mfma_f32_32x32x16_bf16 v[132:147], v[68:71], v[196:199], v[132:147]
    s_add_u32 m0, s26, 16640
    v_exp_f32 v36, v36
    buffer_load_dwordx4 v[2:3], s[96:99], 0 idxen offen lds
    v_exp_f32 v37, v37
    ds_read_u16 v2, v19 offset:512
    v_exp_f32 v38, v38
    v_exp_f32 v39, v39
    v_add_f32 v36, 1.0, v36
    v_add_f32 v37, 1.0, v37
    v_mfma_f32_32x32x16_bf16 v[148:163], v[84:87], v[196:199], v[148:163]
    ds_read_b128 v[184:187], v21 offset:4736
    v_rcp_f32 v36, v36
    ds_read_b128 v[188:191], v21 offset:4992
    v_rcp_f32 v37, v37
    v_exp_f32 v40, v40
    v_exp_f32 v41, v41
    v_add_f32 v38, 1.0, v38
    v_mfma_f32_32x32x16_bf16 v[132:147], v[72:75], v[200:203], v[132:147]
    ds_read_u8 v21, v17 offset:256
    v_add_f32 v39, 1.0, v39
    s_add_u32 m0, s26, 17680
    v_rcp_f32 v38, v38
    buffer_load_dwordx4 v[4:5], s[96:99], 0 idxen offen lds
    v_rcp_f32 v39, v39
    ds_read_u16 v4, v19 offset:576
    v_mul_f32 v52, v36, v52
    v_mul_f32 v53, v37, v53
    v_exp_f32 v42, v42
    v_mfma_f32_32x32x16_bf16 v[148:163], v[88:91], v[200:203], v[148:163]
    v_exp_f32 v43, v43
    v_add_f32 v40, 1.0, v40
    v_add_f32 v41, 1.0, v41
    v_rcp_f32 v40, v40
    v_rcp_f32 v41, v41
    v_mul_f32 v54, v38, v54
    v_mul_f32 v55, v39, v55
    v_cvt_pk_bf16_f32 v36, v36, v37
    s_sub_u32 s28, s28, 1
    s_cbranch_scc1 TAIL1
ENT1:
    v_mfma_f32_32x32x16_bf16 v[68:83], v[164:167], v[220:223], 0
    ds_read_b128 v[196:199], v12
    v_and_b32 v10, 0x7ffff, v10
    s_add_u32 m0, s26, 18720
    v_cvt_pk_bf16_f32 v52, v52, v53
    buffer_load_dwordx4 v[6:7], s[96:99], 0 idxen offen lds
    v_exp_f32 v44, v44
    ds_read_u16 v6, v19 offset:640
    v_exp_f32 v45, v45
    v_add_f32 v42, 1.0, v42
    v_add_f32 v43, 1.0, v43
    v_rcp_f32 v42, v42
    v_mfma_f32_32x32x16_bf16 v[68:83], v[168:171], v[224:227], v[68:83]
    ds_read_b128 v[200:203], v13
    v_rcp_f32 v43, v43
    s_add_u32 m0, s26, 19760
    v_mul_f32 v56, v40, v56
    buffer_load_dwordx4 v[8:9], s[96:99], 0 idxen offen lds
    v_mul_f32 v57, v41, v57
    ds_read_u16 v8, v19 offset:704
    v_cvt_pk_bf16_f32 v37, v38, v39
    s_mov_b32 m0, s27
    v_cvt_pk_bf16_f32 v53, v54, v55
    buffer_load_dwordx4 v[10:11], s[12:15], 0 idxen offen lds
    v_exp_f32 v46, v46
    s_xor_b32 s27, s27, s39
    v_exp_f32 v47, v47
    v_mfma_f32_32x32x16_bf16 v[68:83], v[180:183], v[192:195], v[68:83]
    ds_read_b128 v[180:183], v15 offset:2048
    v_add_f32 v44, 1.0, v44
    ds_read_u16 v12, v18 offset:8
    v_add_f32 v45, 1.0, v45
    ds_read_u16 v13, v18 offset:10
    v_rcp_f32 v44, v44
    v_rcp_f32 v45, v45
    v_mul_f32 v58, v42, v58
    v_mul_f32 v59, v43, v59
    v_cvt_pk_bf16_f32 v38, v40, v41
    v_cvt_pk_bf16_f32 v54, v56, v57
    v_mfma_f32_32x32x16_bf16 v[84:99], v[172:175], v[220:223], 0
    v_exp_f32 v48, v48
    v_exp_f32 v49, v49
    v_add_f32 v46, 1.0, v46
    v_add_f32 v47, 1.0, v47
    v_rcp_f32 v46, v46
    v_rcp_f32 v47, v47
    v_mfma_f32_32x32x16_bf16 v[84:99], v[176:179], v[224:227], v[84:99]
    v_mul_f32 v60, v44, v60
    v_mul_f32 v61, v45, v61
    v_cvt_pk_bf16_f32 v39, v42, v43
    v_cvt_pk_bf16_f32 v55, v58, v59
    v_exp_f32 v50, v50
    v_exp_f32 v51, v51
    v_add_f32 v48, 1.0, v48
    s_waitcnt lgkmcnt(9)
    v_mfma_f32_32x32x16_bf16 v[68:83], v[184:187], v[212:215], v[68:83]
    v_add_f32 v49, 1.0, v49
    v_rcp_f32 v48, v48
    v_rcp_f32 v49, v49
    v_mul_f32 v62, v46, v62
    v_mul_f32 v63, v47, v63
    v_cvt_pk_bf16_f32 v40, v44, v45
    v_cvt_pk_bf16_f32 v56, v60, v61
    v_add_f32 v50, 1.0, v50
    s_waitcnt vmcnt(5)
    v_mfma_f32_32x32x16_bf16 v[68:83], v[188:191], v[216:219], v[68:83]
    ds_read_b128 v[164:167], v1 offset:0
    v_add_f32 v51, 1.0, v51
    ds_read_b128 v[168:171], v1 offset:16
    v_rcp_f32 v50, v50
    ds_read_b128 v[172:175], v1 offset:32
    v_rcp_f32 v51, v51
    ds_read_b128 v[176:179], v1 offset:48
    v_mul_f32 v64, v48, v64
    v_mul_f32 v65, v49, v65
    v_cvt_pk_bf16_f32 v41, v46, v47
    v_cvt_pk_bf16_f32 v57, v62, v63
    v_mul_f32 v66, v50, v66
    v_mul_f32 v67, v51, v67
    v_cvt_pk_bf16_f32 v42, v48, v49
    v_cvt_pk_bf16_f32 v58, v64, v65
    v_cvt_pk_bf16_f32 v43, v50, v51
    v_cvt_pk_bf16_f32 v59, v66, v67
    s_waitcnt lgkmcnt(0)
    v_mfma_f32_32x32x16_bf16 v[100:115], v[36:39], v[196:199], v[100:115]
    s_add_u32 m0, s26, 0
    v_exp_f32 v68, v68
    buffer_load_dwordx4 v[2:3], s[96:99], 0 idxen offen lds
    v_exp_f32 v69, v69
    ds_read_u16 v2, v19 offset:4608
    v_exp_f32 v70, v70
    v_exp_f32 v71, v71
    v_add_f32 v68, 1.0, v68
    v_add_f32 v69, 1.0, v69
    v_mfma_f32_32x32x16_bf16 v[116:131], v[52:55], v[196:199], v[116:131]
    ds_read_b128 v[184:187], v21 offset:4736
    v_rcp_f32 v68, v68
    ds_read_b128 v[188:191], v21 offset:4992
    v_rcp_f32 v69, v69
    v_exp_f32 v72, v72
    v_exp_f32 v73, v73
    v_add_f32 v70, 1.0, v70
    v_mfma_f32_32x32x16_bf16 v[100:115], v[40:43], v[200:203], v[100:115]
    ds_read_u8 v21, v17 offset:4352
    v_add_f32 v71, 1.0, v71
    s_add_u32 m0, s26, 1040
    v_rcp_f32 v70, v70
    buffer_load_dwordx4 v[4:5], s[96:99], 0 idxen offen lds
    v_rcp_f32 v71, v71
    ds_read_u16 v4, v19 offset:4672
    v_mul_f32 v84, v68, v84
    v_mul_f32 v85, v69, v85
    v_exp_f32 v74, v74
    v_mfma_f32_32x32x16_bf16 v[116:131], v[56:59], v[200:203], v[116:131]
    v_exp_f32 v75, v75
    v_add_f32 v72, 1.0, v72
    v_add_f32 v73, 1.0, v73
    v_rcp_f32 v72, v72
    v_rcp_f32 v73, v73
    v_mul_f32 v86, v70, v86
    v_mul_f32 v87, v71, v87
    v_cvt_pk_bf16_f32 v68, v68, v69
    s_sub_u32 s28, s28, 1
    s_cbranch_scc1 TAIL0
ENT2:
    v_mfma_f32_32x32x16_bf16 v[36:51], v[164:167], v[220:223], 0
    ds_read_b128 v[196:199], v12
    v_cvt_pk_bf16_f32 v84, v84, v85
    s_add_u32 m0, s26, 2080
    v_exp_f32 v76, v76
    buffer_load_dwordx4 v[6:7], s[96:99], 0 idxen offen lds
    v_exp_f32 v77, v77
    ds_read_u16 v6, v19 offset:4736
    v_add_f32 v74, 1.0, v74
    v_add_f32 v75, 1.0, v75
    v_rcp_f32 v74, v74
    v_mfma_f32_32x32x16_bf16 v[36:51], v[168:171], v[224:227], v[36:51]
    ds_read_b128 v[200:203], v13
    v_rcp_f32 v75, v75
    s_add_u32 m0, s26, 3120
    v_mul_f32 v88, v72, v88
    buffer_load_dwordx4 v[8:9], s[96:99], 0 idxen offen lds
    v_mul_f32 v89, v73, v89
    ds_read_u16 v8, v19 offset:4800
    v_cvt_pk_bf16_f32 v69, v70, v71
    v_cvt_pk_bf16_f32 v85, v86, v87
    v_exp_f32 v78, v78
    v_exp_f32 v79, v79
    v_mfma_f32_32x32x16_bf16 v[36:51], v[180:183], v[192:195], v[36:51]
    ds_read_b128 v[180:183], v15 offset:3072
    v_add_f32 v76, 1.0, v76
    ds_read_u16 v12, v18 offset:16
    v_add_f32 v77, 1.0, v77
    ds_read_u16 v13, v18 offset:18
    v_rcp_f32 v76, v76
    v_rcp_f32 v77, v77
    v_mul_f32 v90, v74, v90
    v_mul_f32 v91, v75, v91
    v_cvt_pk_bf16_f32 v70, v72, v73
    v_cvt_pk_bf16_f32 v86, v88, v89
    v_mfma_f32_32x32x16_bf16 v[52:67], v[172:175], v[220:223], 0
    v_exp_f32 v80, v80
    v_exp_f32 v81, v81
    v_add_f32 v78, 1.0, v78
    v_add_f32 v79, 1.0, v79
    v_rcp_f32 v78, v78
    v_rcp_f32 v79, v79
    v_mfma_f32_32x32x16_bf16 v[52:67], v[176:179], v[224:227], v[52:67]
    v_mul_f32 v92, v76, v92
    v_mul_f32 v93, v77, v93
    v_cvt_pk_bf16_f32 v71, v74, v75
    v_cvt_pk_bf16_f32 v87, v90, v91
    v_exp_f32 v82, v82
    v_exp_f32 v83, v83
    v_add_f32 v80, 1.0, v80
    s_waitcnt lgkmcnt(9)
    v_mfma_f32_32x32x16_bf16 v[36:51], v[184:187], v[204:207], v[36:51]
    v_add_f32 v81, 1.0, v81
    v_rcp_f32 v80, v80
    v_rcp_f32 v81, v81
    v_mul_f32 v94, v78, v94
    v_mul_f32 v95, v79, v95
    v_cvt_pk_bf16_f32 v72, v76, v77
    v_cvt_pk_bf16_f32 v88, v92, v93
    v_add_f32 v82, 1.0, v82
    s_waitcnt vmcnt(5)
    v_mfma_f32_32x32x16_bf16 v[36:51], v[188:191], v[208:211], v[36:51]
    ds_read_b128 v[164:167], v1 offset:16640
    v_add_f32 v83, 1.0, v83
    ds_read_b128 v[168:171], v1 offset:16656
    v_rcp_f32 v82, v82
    ds_read_b128 v[172:175], v1 offset:16672
    v_rcp_f32 v83, v83
    ds_read_b128 v[176:179], v1 offset:16688
    v_mul_f32 v96, v80, v96
    v_mul_f32 v97, v81, v97
    v_cvt_pk_bf16_f32 v73, v78, v79
    v_cvt_pk_bf16_f32 v89, v94, v95
    v_mul_f32 v98, v82, v98
    v_mul_f32 v99, v83, v99
    v_cvt_pk_bf16_f32 v74, v80, v81
    v_cvt_pk_bf16_f32 v90, v96, v97
    v_cvt_pk_bf16_f32 v75, v82, v83
    v_cvt_pk_bf16_f32 v91, v98, v99
    s_waitcnt vmcnt(4) lgkmcnt(0)
    s_barrier
    v_mfma_f32_32x32x16_bf16 v[132:147], v[68:71], v[196:199], v[132:147]
    s_add_u32 m0, s26, 16640
    v_exp_f32 v36, v36
    buffer_load_dwordx4 v[2:3], s[96:99], 0 idxen offen lds
    v_exp_f32 v37, v37
    ds_read_u16 v2, v19 offset:768
    v_exp_f32 v38, v38
    v_exp_f32 v39, v39
    v_add_f32 v36, 1.0, v36
    v_add_f32 v37, 1.0, v37
    v_mfma_f32_32x32x16_bf16 v[148:163], v[84:87], v[196:199], v[148:163]
    ds_read_b128 v[184:187], v21 offset:4736
    v_rcp_f32 v36, v36
    ds_read_b128 v[188:191], v21 offset:4992
    v_rcp_f32 v37, v37
    v_exp_f32 v40, v40
    v_exp_f32 v41, v41
    v_add_f32 v38, 1.0, v38
    v_mfma_f32_32x32x16_bf16 v[132:147], v[72:75], v[200:203], v[132:147]
    ds_read_u8 v21, v17 offset:512
    v_add_f32 v39, 1.0, v39
    s_add_u32 m0, s26, 17680
    v_rcp_f32 v38, v38
    buffer_load_dwordx4 v[4:5], s[96:99], 0 idxen offen lds
    v_rcp_f32 v39, v39
    ds_read_u16 v4, v19 offset:832
    v_mul_f32 v52, v36, v52
    v_mul_f32 v53, v37, v53
    v_exp_f32 v42, v42
    v_mfma_f32_32x32x16_bf16 v[148:163], v[88:91], v[200:203], v[148:163]
    v_exp_f32 v43, v43
    v_add_f32 v40, 1.0, v40
    v_add_f32 v41, 1.0, v41
    v_rcp_f32 v40, v40
    v_rcp_f32 v41, v41
    v_mul_f32 v54, v38, v54
    v_mul_f32 v55, v39, v55
    v_cvt_pk_bf16_f32 v36, v36, v37
    s_sub_u32 s28, s28, 1
    s_cbranch_scc1 TAIL1
ENT3:
    v_mfma_f32_32x32x16_bf16 v[68:83], v[164:167], v[220:223], 0
    ds_read_b128 v[196:199], v12
    v_cvt_pk_bf16_f32 v52, v52, v53
    s_add_u32 m0, s26, 18720
    v_exp_f32 v44, v44
    buffer_load_dwordx4 v[6:7], s[96:99], 0 idxen offen lds
    v_exp_f32 v45, v45
    ds_read_u16 v6, v19 offset:896
    v_add_f32 v42, 1.0, v42
    v_add_f32 v43, 1.0, v43
    v_rcp_f32 v42, v42
    v_mfma_f32_32x32x16_bf16 v[68:83], v[168:171], v[224:227], v[68:83]
    ds_read_b128 v[200:203], v13
    v_xor_b32 v15, v15, v16
    s_add_u32 m0, s26, 19760
    v_rcp_f32 v43, v43
    buffer_load_dwordx4 v[8:9], s[96:99], 0 idxen offen lds
    v_mul_f32 v56, v40, v56
    ds_read_u16 v8, v19 offset:960
    v_mul_f32 v57, v41, v57
    v_cvt_pk_bf16_f32 v37, v38, v39
    v_cvt_pk_bf16_f32 v53, v54, v55
    v_exp_f32 v46, v46
    v_exp_f32 v47, v47
    v_mfma_f32_32x32x16_bf16 v[68:83], v[180:183], v[192:195], v[68:83]
    ds_read_b128 v[180:183], v15 offset:0
    v_add_f32 v44, 1.0, v44
    ds_read_u16 v12, v18 offset:24
    v_add_f32 v45, 1.0, v45
    ds_read_u16 v13, v18 offset:26
    v_rcp_f32 v44, v44
    v_rcp_f32 v45, v45
    v_mul_f32 v58, v42, v58
    v_mul_f32 v59, v43, v59
    v_cvt_pk_bf16_f32 v38, v40, v41
    v_cvt_pk_bf16_f32 v54, v56, v57
    v_mfma_f32_32x32x16_bf16 v[84:99], v[172:175], v[220:223], 0
    v_exp_f32 v48, v48
    v_exp_f32 v49, v49
    v_add_f32 v46, 1.0, v46
    v_add_f32 v47, 1.0, v47
    v_rcp_f32 v46, v46
    v_rcp_f32 v47, v47
    v_mfma_f32_32x32x16_bf16 v[84:99], v[176:179], v[224:227], v[84:99]
    v_mul_f32 v60, v44, v60
    v_mul_f32 v61, v45, v61
    v_cvt_pk_bf16_f32 v39, v42, v43
    v_cvt_pk_bf16_f32 v55, v58, v59
    v_exp_f32 v50, v50
    v_exp_f32 v51, v51
    v_add_f32 v48, 1.0, v48
    s_waitcnt lgkmcnt(9)
    v_mfma_f32_32x32x16_bf16 v[68:83], v[184:187], v[212:215], v[68:83]
    v_add_f32 v49, 1.0, v49
    v_rcp_f32 v48, v48
    v_rcp_f32 v49, v49
    v_mul_f32 v62, v46, v62
    v_mul_f32 v63, v47, v63
    v_cvt_pk_bf16_f32 v40, v44, v45
    v_cvt_pk_bf16_f32 v56, v60, v61
    v_add_f32 v50, 1.0, v50
    s_waitcnt vmcnt(4)
    v_mfma_f32_32x32x16_bf16 v[68:83], v[188:191], v[216:219], v[68:83]
    ds_read_b128 v[164:167], v1 offset:0
    v_add_u32 v17, 0x200, v17
    ds_read_b128 v[168:171], v1 offset:16
    v_add_u32 v19, 0x200, v19
    ds_read_b128 v[172:175], v1 offset:32
    v_add_u32 v20, 0x200, v20
    ds_read_b128 v[176:179], v1 offset:48
    v_add_u32 v18, 32, v18
    v_add_f32 v51, 1.0, v51
    v_rcp_f32 v50, v50
    v_rcp_f32 v51, v51
    v_mul_f32 v64, v48, v64
    v_mul_f32 v65, v49, v65
    v_cvt_pk_bf16_f32 v41, v46, v47
    v_cvt_pk_bf16_f32 v57, v62, v63
    v_mul_f32 v66, v50, v66
    v_mul_f32 v67, v51, v67
    v_cvt_pk_bf16_f32 v42, v48, v49
    v_cvt_pk_bf16_f32 v58, v64, v65
    v_cvt_pk_bf16_f32 v43, v50, v51
    v_cvt_pk_bf16_f32 v59, v66, v67
    s_add_u32 s35, s28, s30
    s_cmp_lt_u32 s35, 23
    s_cbranch_scc0 LOOP
    s_setprio 2
    s_cmp_lt_u32 s35, 15
    s_cbranch_scc0 LOOP
    s_setprio 1
    s_cmp_lt_u32 s35, 7
    s_cbranch_scc0 LOOP
    s_setprio 0
    s_branch LOOP
TAIL1:
    ds_read_b128 v[196:199], v12
    ds_read_b128 v[200:203], v13
    s_cmp_lg_u32 s33, 0
    s_cbranch_scc1 TAILM1
    s_waitcnt lgkmcnt(0)
    s_add_u32 s35, s52, 0x8000
    buffer_load_dwordx4 v[164:167], v23, s[16:19], s35 offen offset:0
    buffer_load_dwordx4 v[168:171], v23, s[16:19], s35 offen offset:1024
    buffer_load_dwordx4 v[172:175], v23, s[16:19], s35 offen offset:2048
    buffer_load_dwordx4 v[176:179], v23, s[16:19], s35 offen offset:3072
    s_add_u32 s35, s52, 0x9000
    buffer_load_dwordx4 v[180:183], v23, s[16:19], s35 offen offset:0
    buffer_load_dwordx4 v[184:187], v23, s[16:19], s35 offen offset:1024
    buffer_load_dwordx4 v[188:191], v23, s[16:19], s35 offen offset:2048
    buffer_load_dwordx4 v[192:195], v23, s[16:19], s35 offen offset:3072
    ds_read_b128 v[68:71], v24 offset:2080
    ds_read_b128 v[72:75], v24 offset:2096
    ds_read_b128 v[76:79], v24 offset:2112
    ds_read_b128 v[80:83], v24 offset:2128
    ds_read_b128 v[84:87], v24 offset:2144
    ds_read_b128 v[88:91], v24 offset:2160
    ds_read_b128 v[92:95], v24 offset:2176
    ds_read_b128 v[96:99], v24 offset:2192
    ds_read_b128 v[204:207], v25 offset:0
    ds_read_b128 v[208:211], v25 offset:16
    ds_read_b128 v[212:215], v25 offset:2080
    ds_read_b128 v[216:219], v25 offset:2096
    v_and_b32 v2, 31, v0
    v_and_b32 v3, 0xe0, v0
    v_add_u32 v2, s25, v2
    v_add_u32 v4, 25, v2
    v_mov_b32 v5, v3
    v_and_b32 v6, 31, v0
    v_mul_u32_u24 v6, 80, v6
    v_and_b32 v8, 32, v0
    v_add3_u32 v6, v6, v8, s26
    v_bfe_u32 v2, v0, 2, 4
    v_and_b32 v4, 0x30, v23
    v_mul_u32_u24 v8, 80, v2
    v_add3_u32 v8, v8, v4, s26
    v_and_b32 v3, 0xc0, v0
    v_add_u32 v3, v3, v4
    v_mov_b32 v5, v3
    v_add_u32 v2, s25, v2
    v_add_u32 v4, 25, v2
    s_mov_b32 s36, 0xffff0000
    v_cvt_pk_bf16_f32 v52, v52, v53
    v_exp_f32 v44, v44
    v_exp_f32 v45, v45
    v_add_f32 v42, 1.0, v42
    v_add_f32 v43, 1.0, v43
    v_rcp_f32 v42, v42
    v_rcp_f32 v43, v43
    v_mul_f32 v56, v40, v56
    v_mul_f32 v57, v41, v57
    v_cvt_pk_bf16_f32 v37, v38, v39
    v_cvt_pk_bf16_f32 v53, v54, v55
    v_exp_f32 v46, v46
    v_exp_f32 v47, v47
    v_add_f32 v44, 1.0, v44
    v_add_f32 v45, 1.0, v45
    v_rcp_f32 v44, v44
    v_rcp_f32 v45, v45
    v_mul_f32 v58, v42, v58
    v_mul_f32 v59, v43, v59
    v_cvt_pk_bf16_f32 v38, v40, v41
    v_cvt_pk_bf16_f32 v54, v56, v57
    v_exp_f32 v48, v48
    v_exp_f32 v49, v49
    v_add_f32 v46, 1.0, v46
    v_add_f32 v47, 1.0, v47
    v_rcp_f32 v46, v46
    v_rcp_f32 v47, v47
    v_mul_f32 v60, v44, v60
    v_mul_f32 v61, v45, v61
    v_cvt_pk_bf16_f32 v39, v42, v43
    v_cvt_pk_bf16_f32 v55, v58, v59
    v_exp_f32 v50, v50
    v_exp_f32 v51, v51
    v_add_f32 v48, 1.0, v48
    v_add_f32 v49, 1.0, v49
    v_rcp_f32 v48, v48
    v_rcp_f32 v49, v49
    v_mul_f32 v62, v46, v62
    v_mul_f32 v63, v47, v63
    v_cvt_pk_bf16_f32 v40, v44, v45
    v_cvt_pk_bf16_f32 v56, v60, v61
    v_add_f32 v50, 1.0, v50
    v_add_f32 v51, 1.0, v51
    v_rcp_f32 v50, v50
    v_rcp_f32 v51, v51
    v_mul_f32 v64, v48, v64
    v_mul_f32 v65, v49, v65
    v_cvt_pk_bf16_f32 v41, v46, v47
    v_cvt_pk_bf16_f32 v57, v62, v63
    v_mul_f32 v66, v50, v66
    v_mul_f32 v67, v51, v67
    v_cvt_pk_bf16_f32 v42, v48, v49
    v_cvt_pk_bf16_f32 v58, v64, v65
    v_cvt_pk_bf16_f32 v43, v50, v51
    v_cvt_pk_bf16_f32 v59, v66, v67
    s_nop 0
    v_mfma_f32_32x32x16_bf16 v[100:115], v[36:39], v[196:199], v[100:115]
    v_rcp_f32 v132, v132
    v_rcp_f32 v133, v133
    v_rcp_f32 v134, v134
    v_rcp_f32 v135, v135
    v_mfma_f32_32x32x16_bf16 v[116:131], v[52:55], v[196:199], v[116:131]
    v_rcp_f32 v136, v136
    v_rcp_f32 v137, v137
    v_rcp_f32 v138, v138
    v_rcp_f32 v139, v139
    v_mfma_f32_32x32x16_bf16 v[100:115], v[40:43], v[200:203], v[100:115]
    v_rcp_f32 v140, v140
    v_rcp_f32 v141, v141
    v_rcp_f32 v142, v142
    v_rcp_f32 v143, v143
    v_mfma_f32_32x32x16_bf16 v[116:131], v[56:59], v[200:203], v[116:131]
    v_rcp_f32 v144, v144
    v_rcp_f32 v145, v145
    v_rcp_f32 v146, v146
    v_rcp_f32 v147, v147
    v_mul_f32 v148, v132, v148
    v_mul_f32 v149, v133, v149
    v_mul_f32 v150, v134, v150
    v_mul_f32 v151, v135, v151
    v_mul_f32 v152, v136, v152
    v_mul_f32 v153, v137, v153
    v_mul_f32 v154, v138, v154
    v_mul_f32 v155, v139, v155
    v_mul_f32 v156, v140, v156
    v_mul_f32 v157, v141, v157
    v_mul_f32 v158, v142, v158
    v_mul_f32 v159, v143, v159
    v_mul_f32 v160, v144, v160
    v_mul_f32 v161, v145, v161
    v_mul_f32 v162, v146, v162
    v_mul_f32 v163, v147, v163
    ds_read_b128 v[36:39], v24 offset:0
    ds_read_b128 v[40:43], v24 offset:16
    ds_read_b128 v[44:47], v24 offset:32
    ds_read_b128 v[48:51], v24 offset:48
    ds_read_b128 v[52:55], v24 offset:64
    ds_read_b128 v[56:59], v24 offset:80
    ds_read_b128 v[60:63], v24 offset:96
    ds_read_b128 v[64:67], v24 offset:112
    s_waitcnt vmcnt(0) lgkmcnt(8)
    v_mfma_f32_32x32x16_bf16 v[148:163], v[164:167], v[68:71], v[148:163]
    v_rcp_f32 v100, v100
    v_rcp_f32 v101, v101
    v_rcp_f32 v102, v102
    v_rcp_f32 v103, v103
    v_mfma_f32_32x32x16_bf16 v[148:163], v[168:171], v[72:75], v[148:163]
    v_rcp_f32 v104, v104
    v_rcp_f32 v105, v105
    v_rcp_f32 v106, v106
    v_rcp_f32 v107, v107
    v_mfma_f32_32x32x16_bf16 v[148:163], v[172:175], v[76:79], v[148:163]
    v_rcp_f32 v108, v108
    v_rcp_f32 v109, v109
    v_rcp_f32 v110, v110
    v_rcp_f32 v111, v111
    v_mfma_f32_32x32x16_bf16 v[148:163], v[176:179], v[80:83], v[148:163]
    v_rcp_f32 v112, v112
    v_rcp_f32 v113, v113
    v_rcp_f32 v114, v114
    v_rcp_f32 v115, v115
    v_mfma_f32_32x32x16_bf16 v[148:163], v[180:183], v[84:87], v[148:163]
    v_mul_f32 v116, v100, v116
    v_mul_f32 v117, v101, v117
    v_mul_f32 v118, v102, v118
    v_mul_f32 v119, v103, v119
    v_mfma_f32_32x32x16_bf16 v[148:163], v[184:187], v[88:91], v[148:163]
    v_mul_f32 v120, v104, v120
    v_mul_f32 v121, v105, v121
    v_mul_f32 v122, v106, v122
    v_mul_f32 v123, v107, v123
    v_mfma_f32_32x32x16_bf16 v[148:163], v[188:191], v[92:95], v[148:163]
    v_mul_f32 v124, v108, v124
    v_mul_f32 v125, v109, v125
    v_mul_f32 v126, v110, v126
    v_mul_f32 v127, v111, v127
    v_mfma_f32_32x32x16_bf16 v[148:163], v[192:195], v[96:99], v[148:163]
    v_mul_f32 v128, v112, v128
    v_mul_f32 v129, v113, v129
    v_mul_f32 v130, v114, v130
    v_mul_f32 v131, v115, v131
    s_waitcnt lgkmcnt(0)
    s_nop 0
    v_mfma_f32_32x32x16_bf16 v[116:131], v[164:167], v[36:39], v[116:131]
    v_lshlrev_b32 v132, 16, v212
    v_and_b32 v133, s36, v212
    v_lshlrev_b32 v134, 16, v213
    v_and_b32 v135, s36, v213
    v_lshlrev_b32 v136, 16, v214
    v_and_b32 v137, s36, v214
    v_lshlrev_b32 v138, 16, v215
    v_mfma_f32_32x32x16_bf16 v[116:131], v[168:171], v[40:43], v[116:131]
    v_and_b32 v139, s36, v215
    v_lshlrev_b32 v140, 16, v216
    v_and_b32 v141, s36, v216
    v_lshlrev_b32 v142, 16, v217
    v_and_b32 v143, s36, v217
    v_lshlrev_b32 v144, 16, v218
    v_and_b32 v145, s36, v218
    v_mfma_f32_32x32x16_bf16 v[116:131], v[172:175], v[44:47], v[116:131]
    v_lshlrev_b32 v146, 16, v219
    v_and_b32 v147, s36, v219
    v_max_f32 v148, 0, v148
    v_max_f32 v149, 0, v149
    v_add_f32 v148, v148, v132
    v_add_f32 v149, v149, v133
    v_cvt_pk_bf16_f32 v212, v148, v149
    v_mfma_f32_32x32x16_bf16 v[116:131], v[176:179], v[48:51], v[116:131]
    v_max_f32 v150, 0, v150
    v_max_f32 v151, 0, v151
    v_add_f32 v150, v150, v134
    v_add_f32 v151, v151, v135
    v_cvt_pk_bf16_f32 v213, v150, v151
    v_max_f32 v152, 0, v152
    v_max_f32 v153, 0, v153
    v_mfma_f32_32x32x16_bf16 v[116:131], v[180:183], v[52:55], v[116:131]
    v_add_f32 v152, v152, v136
    v_add_f32 v153, v153, v137
    v_cvt_pk_bf16_f32 v214, v152, v153
    v_max_f32 v154, 0, v154
    v_max_f32 v155, 0, v155
    v_add_f32 v154, v154, v138
    v_add_f32 v155, v155, v139
    v_mfma_f32_32x32x16_bf16 v[116:131], v[184:187], v[56:59], v[116:131]
    v_cvt_pk_bf16_f32 v215, v154, v155
    v_max_f32 v156, 0, v156
    v_max_f32 v157, 0, v157
    v_add_f32 v156, v156, v140
    v_add_f32 v157, v157, v141
    v_cvt_pk_bf16_f32 v216, v156, v157
    v_max_f32 v158, 0, v158
    v_mfma_f32_32x32x16_bf16 v[116:131], v[188:191], v[60:63], v[116:131]
    v_max_f32 v159, 0, v159
    v_add_f32 v158, v158, v142
    v_add_f32 v159, v159, v143
    v_cvt_pk_bf16_f32 v217, v158, v159
    v_max_f32 v160, 0, v160
    v_max_f32 v161, 0, v161
    v_add_f32 v160, v160, v144
    v_mfma_f32_32x32x16_bf16 v[116:131], v[192:195], v[64:67], v[116:131]
    v_add_f32 v161, v161, v145
    v_cvt_pk_bf16_f32 v218, v160, v161
    v_max_f32 v162, 0, v162
    v_max_f32 v163, 0, v163
    v_add_f32 v162, v162, v146
    v_add_f32 v163, v163, v147
    v_cvt_pk_bf16_f32 v219, v162, v163
    v_lshlrev_b32 v100, 16, v204
    v_and_b32 v101, s36, v204
    v_lshlrev_b32 v102, 16, v205
    v_and_b32 v103, s36, v205
    v_lshlrev_b32 v104, 16, v206
    v_and_b32 v105, s36, v206
    v_lshlrev_b32 v106, 16, v207
    v_and_b32 v107, s36, v207
    v_lshlrev_b32 v108, 16, v208
    v_and_b32 v109, s36, v208
    v_lshlrev_b32 v110, 16, v209
    v_and_b32 v111, s36, v209
    v_lshlrev_b32 v112, 16, v210
    v_and_b32 v113, s36, v210
    v_lshlrev_b32 v114, 16, v211
    v_and_b32 v115, s36, v211
    ds_write_b128 v6, v[212:215] offset:16640
    ds_write_b128 v6, v[216:219] offset:16656
    ds_read_b128 v[212:215], v8 offset:16640
    ds_read_b128 v[216:219], v8 offset:17920
    v_max_f32 v116, 0, v116
    v_max_f32 v117, 0, v117
    v_add_f32 v116, v116, v100
    v_add_f32 v117, v117, v101
    v_cvt_pk_bf16_f32 v204, v116, v117
    v_max_f32 v118, 0, v118
    v_max_f32 v119, 0, v119
    v_add_f32 v118, v118, v102
    v_add_f32 v119, v119, v103
    v_cvt_pk_bf16_f32 v205, v118, v119
    v_max_f32 v120, 0, v120
    v_max_f32 v121, 0, v121
    v_add_f32 v120, v120, v104
    v_add_f32 v121, v121, v105
    v_cvt_pk_bf16_f32 v206, v120, v121
    v_max_f32 v122, 0, v122
    v_max_f32 v123, 0, v123
    v_add_f32 v122, v122, v106
    v_add_f32 v123, v123, v107
    v_cvt_pk_bf16_f32 v207, v122, v123
    s_waitcnt lgkmcnt(1)
    buffer_store_dwordx4 v[212:215], v[4:5], s[20:23], 0 idxen offen sc1
    v_add_u32 v4, 16, v4
    s_mov_b32 exec_hi, 0
    s_waitcnt lgkmcnt(0)
    buffer_store_dwordx4 v[216:219], v[4:5], s[20:23], 0 idxen offen sc1
    s_mov_b64 exec, -1
    v_max_f32 v124, 0, v124
    v_max_f32 v125, 0, v125
    v_add_f32 v124, v124, v108
    v_add_f32 v125, v125, v109
    v_cvt_pk_bf16_f32 v208, v124, v125
    v_max_f32 v126, 0, v126
    v_max_f32 v127, 0, v127
    v_add_f32 v126, v126, v110
    v_add_f32 v127, v127, v111
    v_cvt_pk_bf16_f32 v209, v126, v127
    v_max_f32 v128, 0, v128
    v_max_f32 v129, 0, v129
    v_add_f32 v128, v128, v112
    v_add_f32 v129, v129, v113
    v_cvt_pk_bf16_f32 v210, v128, v129
    v_max_f32 v130, 0, v130
    v_max_f32 v131, 0, v131
    v_add_f32 v130, v130, v114
    v_add_f32 v131, v131, v115
    v_cvt_pk_bf16_f32 v211, v130, v131
    ds_write_b128 v6, v[204:207] offset:0
    ds_write_b128 v6, v[208:211] offset:16
    ds_read_b128 v[204:207], v8 offset:0
    ds_read_b128 v[208:211], v8 offset:1280
    s_waitcnt lgkmcnt(1)
    buffer_store_dwordx4 v[204:207], v[2:3], s[20:23], 0 idxen offen sc1
    v_add_u32 v2, 16, v2
    s_mov_b32 exec_hi, 15
    s_waitcnt lgkmcnt(0)
    buffer_store_dwordx4 v[208:211], v[2:3], s[20:23], 0 idxen offen sc1
    s_mov_b64 exec, -1
    s_branch K2_FIN
TAIL0:
    ds_read_b128 v[196:199], v12
    ds_read_b128 v[200:203], v13
    s_cmp_lg_u32 s33, 0
    s_cbranch_scc1 TAILM0
    s_waitcnt lgkmcnt(0)
    s_add_u32 s35, s52, 0x8000
    buffer_load_dwordx4 v[164:167], v23, s[16:19], s35 offen offset:0
    buffer_load_dwordx4 v[168:171], v23, s[16:19], s35 offen offset:1024
    buffer_load_dwordx4 v[172:175], v23, s[16:19], s35 offen offset:2048
    buffer_load_dwordx4 v[176:179], v23, s[16:19], s35 offen offset:3072
    s_add_u32 s35, s52, 0x9000
    buffer_load_dwordx4 v[180:183], v23, s[16:19], s35 offen offset:0
    buffer_load_dwordx4 v[184:187], v23, s[16:19], s35 offen offset:1024
    buffer_load_dwordx4 v[188:191], v23, s[16:19], s35 offen offset:2048
    buffer_load_dwordx4 v[192:195], v23, s[16:19], s35 offen offset:3072
    ds_read_b128 v[36:39], v24 offset:0
    ds_read_b128 v[40:43], v24 offset:16
    ds_read_b128 v[44:47], v24 offset:32
    ds_read_b128 v[48:51], v24 offset:48
    ds_read_b128 v[52:55], v24 offset:64
    ds_read_b128 v[56:59], v24 offset:80
    ds_read_b128 v[60:63], v24 offset:96
    ds_read_b128 v[64:67], v24 offset:112
    ds_read_b128 v[204:207], v25 offset:0
    ds_read_b128 v[208:211], v25 offset:16
    ds_read_b128 v[212:215], v25 offset:2080
    ds_read_b128 v[216:219], v25 offset:2096
    v_and_b32 v2, 31, v0
    v_and_b32 v3, 0xe0, v0
    v_add_u32 v2, s25, v2
    v_add_u32 v4, 25, v2
    v_mov_b32 v5, v3
    v_and_b32 v6, 31, v0
    v_mul_u32_u24 v6, 80, v6
    v_and_b32 v8, 32, v0
    v_add3_u32 v6, v6, v8, s26
    v_bfe_u32 v2, v0, 2, 4
    v_and_b32 v4, 0x30, v23
    v_mul_u32_u24 v8, 80, v2
    v_add3_u32 v8, v8, v4, s26
    v_and_b32 v3, 0xc0, v0
    v_add_u32 v3, v3, v4
    v_mov_b32 v5, v3
    v_add_u32 v2, s25, v2
    v_add_u32 v4, 25, v2
    s_mov_b32 s36, 0xffff0000
    v_cvt_pk_bf16_f32 v84, v84, v85
    v_exp_f32 v76, v76
    v_exp_f32 v77, v77
    v_add_f32 v74, 1.0, v74
    v_add_f32 v75, 1.0, v75
    v_rcp_f32 v74, v74
    v_rcp_f32 v75, v75
    v_mul_f32 v88, v72, v88
    v_mul_f32 v89, v73, v89
    v_cvt_pk_bf16_f32 v69, v70, v71
    v_cvt_pk_bf16_f32 v85, v86, v87
    v_exp_f32 v78, v78
    v_exp_f32 v79, v79
    v_add_f32 v76, 1.0, v76
    v_add_f32 v77, 1.0, v77
    v_rcp_f32 v76, v76
    v_rcp_f32 v77, v77
    v_mul_f32 v90, v74, v90
    v_mul_f32 v91, v75, v91
    v_cvt_pk_bf16_f32 v70, v72, v73
    v_cvt_pk_bf16_f32 v86, v88, v89
    v_exp_f32 v80, v80
    v_exp_f32 v81, v81
    v_add_f32 v78, 1.0, v78
    v_add_f32 v79, 1.0, v79
    v_rcp_f32 v78, v78
    v_rcp_f32 v79, v79
    v_mul_f32 v92, v76, v92
    v_mul_f32 v93, v77, v93
    v_cvt_pk_bf16_f32 v71, v74, v75
    v_cvt_pk_bf16_f32 v87, v90, v91
    v_exp_f32 v82, v82
    v_exp_f32 v83, v83
    v_add_f32 v80, 1.0, v80
    v_add_f32 v81, 1.0, v81
    v_rcp_f32 v80, v80
    v_rcp_f32 v81, v81
    v_mul_f32 v94, v78, v94
    v_mul_f32 v95, v79, v95
    v_cvt_pk_bf16_f32 v72, v76, v77
    v_cvt_pk_bf16_f32 v88, v92, v93
    v_add_f32 v82, 1.0, v82
    v_add_f32 v83, 1.0, v83
    v_rcp_f32 v82, v82
    v_rcp_f32 v83, v83
    v_mul_f32 v96, v80, v96
    v_mul_f32 v97, v81, v97
    v_cvt_pk_bf16_f32 v73, v78, v79
    v_cvt_pk_bf16_f32 v89, v94, v95
    v_mul_f32 v98, v82, v98
    v_mul_f32 v99, v83, v99
    v_cvt_pk_bf16_f32 v74, v80, v81
    v_cvt_pk_bf16_f32 v90, v96, v97
    v_cvt_pk_bf16_f32 v75, v82, v83
    v_cvt_pk_bf16_f32 v91, v98, v99
    s_nop 0
    v_mfma_f32_32x32x16_bf16 v[132:147], v[68:71], v[196:199], v[132:147]
    v_rcp_f32 v100, v100
    v_rcp_f32 v101, v101
    v_rcp_f32 v102, v102
    v_rcp_f32 v103, v103
    v_mfma_f32_32x32x16_bf16 v[148:163], v[84:87], v[196:199], v[148:163]
    v_rcp_f32 v104, v104
    v_rcp_f32 v105, v105
    v_rcp_f32 v106, v106
    v_rcp_f32 v107, v107
    v_mfma_f32_32x32x16_bf16 v[132:147], v[72:75], v[200:203], v[132:147]
    v_rcp_f32 v108, v108
    v_rcp_f32 v109, v109
    v_rcp_f32 v110, v110
    v_rcp_f32 v111, v111
    v_mfma_f32_32x32x16_bf16 v[148:163], v[88:91], v[200:203], v[148:163]
    v_rcp_f32 v112, v112
    v_rcp_f32 v113, v113
    v_rcp_f32 v114, v114
    v_rcp_f32 v115, v115
    v_mul_f32 v116, v100, v116
    v_mul_f32 v117, v101, v117
    v_mul_f32 v118, v102, v118
    v_mul_f32 v119, v103, v119
    v_mul_f32 v120, v104, v120
    v_mul_f32 v121, v105, v121
    v_mul_f32 v122, v106, v122
    v_mul_f32 v123, v107, v123
    v_mul_f32 v124, v108, v124
    v_mul_f32 v125, v109, v125
    v_mul_f32 v126, v110, v126
    v_mul_f32 v127, v111, v127
    v_mul_f32 v128, v112, v128
    v_mul_f32 v129, v113, v129
    v_mul_f32 v130, v114, v130
    v_mul_f32 v131, v115, v131
    ds_read_b128 v[68:71], v24 offset:2080
    ds_read_b128 v[72:75], v24 offset:2096
    ds_read_b128 v[76:79], v24 offset:2112
    ds_read_b128 v[80:83], v24 offset:2128
    ds_read_b128 v[84:87], v24 offset:2144
    ds_read_b128 v[88:91], v24 offset:2160
    ds_read_b128 v[92:95], v24 offset:2176
    ds_read_b128 v[96:99], v24 offset:2192
    s_waitcnt vmcnt(0) lgkmcnt(8)
    v_mfma_f32_32x32x16_bf16 v[116:131], v[164:167], v[36:39], v[116:131]
    v_rcp_f32 v132, v132
    v_rcp_f32 v133, v133
    v_rcp_f32 v134, v134
    v_rcp_f32 v135, v135
    v_mfma_f32_32x32x16_bf16 v[116:131], v[168:171], v[40:43], v[116:131]
    v_rcp_f32 v136, v136
    v_rcp_f32 v137, v137
    v_rcp_f32 v138, v138
    v_rcp_f32 v139, v139
    v_mfma_f32_32x32x16_bf16 v[116:131], v[172:175], v[44:47], v[116:131]
    v_rcp_f32 v140, v140
    v_rcp_f32 v141, v141
    v_rcp_f32 v142, v142
    v_rcp_f32 v143, v143
    v_mfma_f32_32x32x16_bf16 v[116:131], v[176:179], v[48:51], v[116:131]
    v_rcp_f32 v144, v144
    v_rcp_f32 v145, v145
    v_rcp_f32 v146, v146
    v_rcp_f32 v147, v147
    v_mfma_f32_32x32x16_bf16 v[116:131], v[180:183], v[52:55], v[116:131]
    v_mul_f32 v148, v132, v148
    v_mul_f32 v149, v133, v149
    v_mul_f32 v150, v134, v150
    v_mul_f32 v151, v135, v151
    v_mfma_f32_32x32x16_bf16 v[116:131], v[184:187], v[56:59], v[116:131]
    v_mul_f32 v152, v136, v152
    v_mul_f32 v153, v137, v153
    v_mul_f32 v154, v138, v154
    v_mul_f32 v155, v139, v155
    v_mfma_f32_32x32x16_bf16 v[116:131], v[188:191], v[60:63], v[116:131]
    v_mul_f32 v156, v140, v156
    v_mul_f32 v157, v141, v157
    v_mul_f32 v158, v142, v158
    v_mul_f32 v159, v143, v159
    v_mfma_f32_32x32x16_bf16 v[116:131], v[192:195], v[64:67], v[116:131]
    v_mul_f32 v160, v144, v160
    v_mul_f32 v161, v145, v161
    v_mul_f32 v162, v146, v162
    v_mul_f32 v163, v147, v163
    s_waitcnt lgkmcnt(0)
    s_nop 0
    v_mfma_f32_32x32x16_bf16 v[148:163], v[164:167], v[68:71], v[148:163]
    v_lshlrev_b32 v100, 16, v204
    v_and_b32 v101, s36, v204
    v_lshlrev_b32 v102, 16, v205
    v_and_b32 v103, s36, v205
    v_lshlrev_b32 v104, 16, v206
    v_and_b32 v105, s36, v206
    v_lshlrev_b32 v106, 16, v207
    v_mfma_f32_32x32x16_bf16 v[148:163], v[168:171], v[72:75], v[148:163]
    v_and_b32 v107, s36, v207
    v_lshlrev_b32 v108, 16, v208
    v_and_b32 v109, s36, v208
    v_lshlrev_b32 v110, 16, v209
    v_and_b32 v111, s36, v209
    v_lshlrev_b32 v112, 16, v210
    v_and_b32 v113, s36, v210
    v_mfma_f32_32x32x16_bf16 v[148:163], v[172:175], v[76:79], v[148:163]
    v_lshlrev_b32 v114, 16, v211
    v_and_b32 v115, s36, v211
    v_max_f32 v116, 0, v116
    v_max_f32 v117, 0, v117
    v_add_f32 v116, v116, v100
    v_add_f32 v117, v117, v101
    v_cvt_pk_bf16_f32 v204, v116, v117
    v_mfma_f32_32x32x16_bf16 v[148:163], v[176:179], v[80:83], v[148:163]
    v_max_f32 v118, 0, v118
    v_max_f32 v119, 0, v119
    v_add_f32 v118, v118, v102
    v_add_f32 v119, v119, v103
    v_cvt_pk_bf16_f32 v205, v118, v119
    v_max_f32 v120, 0, v120
    v_max_f32 v121, 0, v121
    v_mfma_f32_32x32x16_bf16 v[148:163], v[180:183], v[84:87], v[148:163]
    v_add_f32 v120, v120, v104
    v_add_f32 v121, v121, v105
    v_cvt_pk_bf16_f32 v206, v120, v121
    v_max_f32 v122, 0, v122
    v_max_f32 v123, 0, v123
    v_add_f32 v122, v122, v106
    v_add_f32 v123, v123, v107
    v_mfma_f32_32x32x16_bf16 v[148:163], v[184:187], v[88:91], v[148:163]
    v_cvt_pk_bf16_f32 v207, v122, v123
    v_max_f32 v124, 0, v124
    v_max_f32 v125, 0, v125
    v_add_f32 v124, v124, v108
    v_add_f32 v125, v125, v109
    v_cvt_pk_bf16_f32 v208, v124, v125
    v_max_f32 v126, 0, v126
    v_mfma_f32_32x32x16_bf16 v[148:163], v[188:191], v[92:95], v[148:163]
    v_max_f32 v127, 0, v127
    v_add_f32 v126, v126, v110
    v_add_f32 v127, v127, v111
    v_cvt_pk_bf16_f32 v209, v126, v127
    v_max_f32 v128, 0, v128
    v_max_f32 v129, 0, v129
    v_add_f32 v128, v128, v112
    v_mfma_f32_32x32x16_bf16 v[148:163], v[192:195], v[96:99], v[148:163]
    v_add_f32 v129, v129, v113
    v_cvt_pk_bf16_f32 v210, v128, v129
    v_max_f32 v130, 0, v130
    v_max_f32 v131, 0, v131
    v_add_f32 v130, v130, v114
    v_add_f32 v131, v131, v115
    v_cvt_pk_bf16_f32 v211, v130, v131
    v_lshlrev_b32 v132, 16, v212
    v_and_b32 v133, s36, v212
    v_lshlrev_b32 v134, 16, v213
    v_and_b32 v135, s36, v213
    v_lshlrev_b32 v136, 16, v214
    v_and_b32 v137, s36, v214
    v_lshlrev_b32 v138, 16, v215
    v_and_b32 v139, s36, v215
    v_lshlrev_b32 v140, 16, v216
    v_and_b32 v141, s36, v216
    v_lshlrev_b32 v142, 16, v217
    v_and_b32 v143, s36, v217
    v_lshlrev_b32 v144, 16, v218
    v_and_b32 v145, s36, v218
    v_lshlrev_b32 v146, 16, v219
    v_and_b32 v147, s36, v219
    ds_write_b128 v6, v[204:207] offset:0
    ds_write_b128 v6, v[208:211] offset:16
    ds_read_b128 v[204:207], v8 offset:0
    ds_read_b128 v[208:211], v8 offset:1280
    v_max_f32 v148, 0, v148
    v_max_f32 v149, 0, v149
    v_add_f32 v148, v148, v132
    v_add_f32 v149, v149, v133
    v_cvt_pk_bf16_f32 v212, v148, v149
    v_max_f32 v150, 0, v150
    v_max_f32 v151, 0, v151
    v_add_f32 v150, v150, v134
    v_add_f32 v151, v151, v135
    v_cvt_pk_bf16_f32 v213, v150, v151
    v_max_f32 v152, 0, v152
    v_max_f32 v153, 0, v153
    v_add_f32 v152, v152, v136
    v_add_f32 v153, v153, v137
    v_cvt_pk_bf16_f32 v214, v152, v153
    v_max_f32 v154, 0, v154
    v_max_f32 v155, 0, v155
    v_add_f32 v154, v154, v138
    v_add_f32 v155, v155, v139
    v_cvt_pk_bf16_f32 v215, v154, v155
    s_waitcnt lgkmcnt(1)
    buffer_store_dwordx4 v[204:207], v[2:3], s[20:23], 0 idxen offen sc1
    v_add_u32 v2, 16, v2
    s_mov_b32 exec_hi, 15
    s_waitcnt lgkmcnt(0)
    buffer_store_dwordx4 v[208:211], v[2:3], s[20:23], 0 idxen offen sc1
    s_mov_b64 exec, -1
    v_max_f32 v156, 0, v156
    v_max_f32 v157, 0, v157
    v_add_f32 v156, v156, v140
    v_add_f32 v157, v157, v141
    v_cvt_pk_bf16_f32 v216, v156, v157
    v_max_f32 v158, 0, v158
    v_max_f32 v159, 0, v159
    v_add_f32 v158, v158, v142
    v_add_f32 v159, v159, v143
    v_cvt_pk_bf16_f32 v217, v158, v159
    v_max_f32 v160, 0, v160
    v_max_f32 v161, 0, v161
    v_add_f32 v160, v160, v144
    v_add_f32 v161, v161, v145
    v_cvt_pk_bf16_f32 v218, v160, v161
    v_max_f32 v162, 0, v162
    v_max_f32 v163, 0, v163
    v_add_f32 v162, v162, v146
    v_add_f32 v163, v163, v147
    v_cvt_pk_bf16_f32 v219, v162, v163
    ds_write_b128 v6, v[212:215] offset:16640
    ds_write_b128 v6, v[216:219] offset:16656
    ds_read_b128 v[212:215], v8 offset:16640
    ds_read_b128 v[216:219], v8 offset:17920
    s_waitcnt lgkmcnt(1)
    buffer_store_dwordx4 v[212:215], v[4:5], s[20:23], 0 idxen offen sc1
    v_add_u32 v4, 16, v4
    s_mov_b32 exec_hi, 0
    s_waitcnt lgkmcnt(0)
    buffer_store_dwordx4 v[216:219], v[4:5], s[20:23], 0 idxen offen sc1
    s_mov_b64 exec, -1
K2_FIN:
K2_END:
    s_endpgm
TAILM1:
    v_cvt_pk_bf16_f32 v52, v52, v53
    v_exp_f32 v44, v44
    v_exp_f32 v45, v45
    v_add_f32 v42, 1.0, v42
    v_add_f32 v43, 1.0, v43
    v_rcp_f32 v42, v42
    v_rcp_f32 v43, v43
    v_mul_f32 v56, v40, v56
    v_mul_f32 v57, v41, v57
    v_cvt_pk_bf16_f32 v37, v38, v39
    v_cvt_pk_bf16_f32 v53, v54, v55
    v_exp_f32 v46, v46
    v_exp_f32 v47, v47
    v_add_f32 v44, 1.0, v44
    v_add_f32 v45, 1.0, v45
    v_rcp_f32 v44, v44
    v_rcp_f32 v45, v45
    v_mul_f32 v58, v42, v58
    v_mul_f32 v59, v43, v59
    v_cvt_pk_bf16_f32 v38, v40, v41
    v_cvt_pk_bf16_f32 v54, v56, v57
    v_exp_f32 v48, v48
    v_exp_f32 v49, v49
    v_add_f32 v46, 1.0, v46
    v_add_f32 v47, 1.0, v47
    v_rcp_f32 v46, v46
    v_rcp_f32 v47, v47
    v_mul_f32 v60, v44, v60
    v_mul_f32 v61, v45, v61
    v_cvt_pk_bf16_f32 v39, v42, v43
    v_cvt_pk_bf16_f32 v55, v58, v59
    v_exp_f32 v50, v50
    v_exp_f32 v51, v51
    v_add_f32 v48, 1.0, v48
    v_add_f32 v49, 1.0, v49
    v_rcp_f32 v48, v48
    v_rcp_f32 v49, v49
    v_mul_f32 v62, v46, v62
    v_mul_f32 v63, v47, v63
    v_cvt_pk_bf16_f32 v40, v44, v45
    v_cvt_pk_bf16_f32 v56, v60, v61
    v_add_f32 v50, 1.0, v50
    v_add_f32 v51, 1.0, v51
    v_rcp_f32 v50, v50
    v_rcp_f32 v51, v51
    v_mul_f32 v64, v48, v64
    v_mul_f32 v65, v49, v65
    v_cvt_pk_bf16_f32 v41, v46, v47
    v_cvt_pk_bf16_f32 v57, v62, v63
    v_mul_f32 v66, v50, v66
    v_mul_f32 v67, v51, v67
    v_cvt_pk_bf16_f32 v42, v48, v49
    v_cvt_pk_bf16_f32 v58, v64, v65
    v_cvt_pk_bf16_f32 v43, v50, v51
    v_cvt_pk_bf16_f32 v59, v66, v67
    s_waitcnt lgkmcnt(0)
    v_mfma_f32_32x32x16_bf16 v[100:115], v[36:39], v[196:199], v[100:115]
    v_mfma_f32_32x32x16_bf16 v[116:131], v[52:55], v[196:199], v[116:131]
    v_mfma_f32_32x32x16_bf16 v[100:115], v[40:43], v[200:203], v[100:115]
    v_mfma_f32_32x32x16_bf16 v[116:131], v[56:59], v[200:203], v[116:131]
    s_branch NEXTROUND
TAILM0:
    v_cvt_pk_bf16_f32 v84, v84, v85
    v_exp_f32 v76, v76
    v_exp_f32 v77, v77
    v_add_f32 v74, 1.0, v74
    v_add_f32 v75, 1.0, v75
    v_rcp_f32 v74, v74
    v_rcp_f32 v75, v75
    v_mul_f32 v88, v72, v88
    v_mul_f32 v89, v73, v89
    v_cvt_pk_bf16_f32 v69, v70, v71
    v_cvt_pk_bf16_f32 v85, v86, v87
    v_exp_f32 v78, v78
    v_exp_f32 v79, v79
    v_add_f32 v76, 1.0, v76
    v_add_f32 v77, 1.0, v77
    v_rcp_f32 v76, v76
    v_rcp_f32 v77, v77
    v_mul_f32 v90, v74, v90
    v_mul_f32 v91, v75, v91
    v_cvt_pk_bf16_f32 v70, v72, v73
    v_cvt_pk_bf16_f32 v86, v88, v89
    v_exp_f32 v80, v80
    v_exp_f32 v81, v81
    v_add_f32 v78, 1.0, v78
    v_add_f32 v79, 1.0, v79
    v_rcp_f32 v78, v78
    v_rcp_f32 v79, v79
    v_mul_f32 v92, v76, v92
    v_mul_f32 v93, v77, v93
    v_cvt_pk_bf16_f32 v71, v74, v75
    v_cvt_pk_bf16_f32 v87, v90, v91
    v_exp_f32 v82, v82
    v_exp_f32 v83, v83
    v_add_f32 v80, 1.0, v80
    v_add_f32 v81, 1.0, v81
    v_rcp_f32 v80, v80
    v_rcp_f32 v81, v81
    v_mul_f32 v94, v78, v94
    v_mul_f32 v95, v79, v95
    v_cvt_pk_bf16_f32 v72, v76, v77
    v_cvt_pk_bf16_f32 v88, v92, v93
    v_add_f32 v82, 1.0, v82
    v_add_f32 v83, 1.0, v83
    v_rcp_f32 v82, v82
    v_rcp_f32 v83, v83
    v_mul_f32 v96, v80, v96
    v_mul_f32 v97, v81, v97
    v_cvt_pk_bf16_f32 v73, v78, v79
    v_cvt_pk_bf16_f32 v89, v94, v95
    v_mul_f32 v98, v82, v98
    v_mul_f32 v99, v83, v99
    v_cvt_pk_bf16_f32 v74, v80, v81
    v_cvt_pk_bf16_f32 v90, v96, v97
    v_cvt_pk_bf16_f32 v75, v82, v83
    v_cvt_pk_bf16_f32 v91, v98, v99
    s_waitcnt lgkmcnt(0)
    v_mfma_f32_32x32x16_bf16 v[132:147], v[68:71], v[196:199], v[132:147]
    v_mfma_f32_32x32x16_bf16 v[148:163], v[84:87], v[196:199], v[148:163]
    v_mfma_f32_32x32x16_bf16 v[132:147], v[72:75], v[200:203], v[132:147]
    v_mfma_f32_32x32x16_bf16 v[148:163], v[88:91], v[200:203], v[148:163]
NEXTROUND:
    v_lshrrev_b32 v14, 19, v28
    v_min_u32 v14, s31, v14
    v_add_u32 v28, v28, v14
    v_lshlrev_b32 v14, 19, v14
    v_sub_u32 v28, v28, v14
    v_lshrrev_b32 v14, 19, v29
    v_min_u32 v14, s31, v14
    v_add_u32 v29, v29, v14
    v_lshlrev_b32 v14, 19, v14
    v_sub_u32 v29, v29, v14
    v_lshrrev_b32 v14, 19, v30
    v_min_u32 v14, s31, v14
    v_add_u32 v30, v30, v14
    v_lshlrev_b32 v14, 19, v14
    v_sub_u32 v30, v30, v14
    v_lshrrev_b32 v14, 19, v31
    v_min_u32 v14, s31, v14
    v_add_u32 v31, v31, v14
    v_lshlrev_b32 v14, 19, v14
    v_sub_u32 v31, v31, v14
    s_mov_b32 s32, 0
    s_mov_b32 s31, 64
    s_waitcnt vmcnt(0) lgkmcnt(0)
    s_barrier
    s_branch ROUND
CODE_END:
.section .rodata,"a"
.p2align 6
.amdhsa_kernel gsort_kernel
  .amdhsa_next_free_vgpr 240
  .amdhsa_next_free_sgpr 72
  .amdhsa_accum_offset 240
  .amdhsa_group_segment_fixed_size 0
  .amdhsa_kernarg_size 96
  .amdhsa_user_sgpr_count 2
  .amdhsa_user_sgpr_kernarg_segment_ptr 1
  .amdhsa_system_sgpr_workgroup_id_x 1
  .amdhsa_float_denorm_mode_32 3
.end_amdhsa_kernel
.p2align 6
.amdhsa_kernel gmain_kernel
  .amdhsa_next_free_vgpr 244
  .amdhsa_next_free_sgpr 102
  .amdhsa_accum_offset 244
  .amdhsa_group_segment_fixed_size 0
  .amdhsa_kernarg_size 96
  .amdhsa_user_sgpr_count 2
  .amdhsa_user_sgpr_kernarg_segment_ptr 1
  .amdhsa_system_sgpr_workgroup_id_x 1
  .amdhsa_float_denorm_mode_32 3
.end_amdhsa_kernel
```
